```python
import torch

def _softmax(x, axis=-1):
    return torch.softmax(x, dim=axis)

def _gelu(x):
    return torch.nn.functional.gelu(x, approximate='tanh')

def _silu(x):
    return torch.nn.functional.silu(x)

def _sigmoid(x):
    return torch.sigmoid(x)

def _layernorm(x, axis=-1, eps=1e-05):
    m = x.mean(dim=axis, keepdim=True)
    v = x.var(dim=axis, keepdim=True, unbiased=False)
    return (x - m) / torch.sqrt(v + eps)

def _scatter_add(tgt, idx, src, axis=0):
    return tgt.clone().index_add_(axis, idx, src)

def _segment_sum(src, seg, n):
    out = torch.zeros((n,) + src.shape[1:], dtype=src.dtype)
    return out.index_add_(0, seg, src)

def _pad(x, pw):
    flat = tuple((v for pair in reversed(pw) for v in pair))
    return torch.nn.functional.pad(x, flat)
kernel_name = 'adaLN_cond__gqa_block_cached__dense_activation_silu__decode'

def setup_inputs():

    _w = lambda a: (lambda t: t.to(torch.bfloat16) if t.is_floating_point() else t)(torch.as_tensor(a))

    def _A_setup():
        B, Sq, D = (1, 1, 512)
        Hq, Hkv, Sk, Dh = (32, 8, 65536, 128)
        assert Hq % Hkv == 0, (Hq, Hkv)
        return {'x': _w((lambda *s: torch.randn(*s, dtype=torch.bfloat16) * 0.1)(B, Sq, D)), 'k_cache': _w((lambda *s: torch.randn(*s, dtype=torch.bfloat16) * 0.8)(B, Hkv, Sk, Dh)), 'v_cache': _w((lambda *s: torch.randn(*s, dtype=torch.bfloat16) * 3.2)(B, Hkv, Sk, Dh)), 'wq': _w((lambda *s: torch.randn(*s, dtype=torch.bfloat16) * 0.8)(D, Hq * Dh) * D ** (-0.5)), 'wo': _w((lambda *s: torch.randn(*s, dtype=torch.bfloat16) * 3.2)(Hq * Dh, D) * (Hq * Dh) ** (-0.5))}
    _A_in = _A_setup()

    def _B_setup():
        B, S, D, F = (1, 1, 512, 1792)
        return {'x': _w((lambda *s: torch.randn(*s, dtype=torch.bfloat16) * 0.1)(B, S, D)), 'w1': _w((lambda *s: torch.randn(*s, dtype=torch.bfloat16) * 12.8)(D, F) * D ** (-0.5)), 'w2': _w((lambda *s: torch.randn(*s, dtype=torch.bfloat16) * 12.8)(F, D) * F ** (-0.5))}
    _B_in = _B_setup()
    return {'A_x': _A_in['x'], 'A_k_cache': _A_in['k_cache'], 'A_v_cache': _A_in['v_cache'], 'A_wq': _A_in['wq'], 'A_wo': _A_in['wo'], 'B_x': _B_in['x'], 'B_w1': _B_in['w1'], 'B_w2': _B_in['w2'], 'c': _w((lambda *s: torch.randn(*s, dtype=torch.bfloat16) * 0.2)(1, 512) * 8.0), 'w_mod': _w((lambda *s: torch.randn(*s, dtype=torch.bfloat16) * 0.2)(512, 6 * 512) * 512 ** (-0.5) * 8.0)}

def reference(A_x, A_k_cache, A_v_cache, A_wq, A_wo, B_x, B_w1, B_w2, c, w_mod):

    def _A_ref(x, k_cache, v_cache, wq, wo):
        B, Sq, D = x.shape
        Hq, Dh = (32, 128)
        Hkv = k_cache.shape[1]
        rep = Hq // Hkv
        q = (lambda x, *d: x.permute(*d))((x @ wq).reshape(B, Sq, Hq, Dh), 0, 2, 1, 3)
        k = (lambda x, n, axis: torch.repeat_interleave(x, n, dim=axis))(k_cache, rep, axis=1)
        v = (lambda x, n, axis: torch.repeat_interleave(x, n, dim=axis))(v_cache, rep, axis=1)
        scores = torch.einsum('bhqd,bhkd->bhqk', q, k) * Dh ** (-0.5)
        p = _softmax(scores, axis=-1)
        o = torch.einsum('bhqk,bhkd->bhqd', p, v)
        return (lambda x, *d: x.permute(*d))(o, 0, 2, 1, 3).reshape(B, Sq, Hq * Dh) @ wo

    def _B_ref(x, w1, w2):
        h = torch.einsum('bsd,df->bsf', x, w1)
        h = _silu(h)
        out = torch.einsum('bsf,fd->bsd', h, w2)
        return out
    x = A_x
    mod = (_silu(c) @ w_mod).reshape(c.shape[0], 6, 1, -1)
    sa, ca, ga, sb, cb, gb = (mod[:, 0].clone(), mod[:, 1].clone(), mod[:, 2].clone(), mod[:, 3].clone(), mod[:, 4].clone(), mod[:, 5].clone())
    h = _layernorm(x, axis=-1) * (1 + ca) + sa
    x = x + ga * _A_ref(h, A_k_cache, A_v_cache, A_wq, A_wo)
    h = _layernorm(x, axis=-1) * (1 + cb) + sb
    x = x + gb * _B_ref(h, B_w1, B_w2)
    return x
```

```asm
; @launch grid=(256,1,1) block=(512,1,1) lds=163840
.amdgcn_target "amdgcn-amd-amdhsa--gfx950"
.text
.globl adaLN_cond__gqa_block_cached__dense_activation_silu__decode_kernel
.p2align 8
.type adaLN_cond__gqa_block_cached__dense_activation_silu__decode_kernel,@function
adaLN_cond__gqa_block_cached__dense_activation_silu__decode_kernel:
    s_cmp_ge_u32 s2, 256
    s_cbranch_scc1 L_exit
    v_lshrrev_b32 v1, 6, v0
    v_and_b32 v0, 63, v0
    v_readfirstlane_b32 s82, v1
    v_mov_b32 v2, 0
    s_cmp_lg_u32 s82, 3
    s_cbranch_scc1 L_noinit
    v_lshlrev_b32 v1, 2, v0
    v_cmp_eq_u32 vcc, 16, v0
    v_mov_b32 v3, 256
    s_nop 0
    v_cndmask_b32 v3, v2, v3, vcc
    ds_write_b32 v1, v3
    s_waitcnt lgkmcnt(0)
L_noinit:
    s_load_dwordx16 s[16:31], s[0:1], 0
    s_load_dwordx8 s[32:39], s[0:1], 64
    s_load_dwordx2 s[40:41], s[0:1], 96
    s_barrier
    s_and_b32 s3, s82, 3
    s_and_b32 s4, s2, 7
    s_lshr_b32 s5, s2, 3
    s_mov_b32 s83, 0xffff0000
    v_lshlrev_b32 v1, 4, v0
    s_cmp_ge_u32 s82, 4
    s_cbranch_scc1 L_T
    s_cmp_ge_u32 s2, 192
    s_cbranch_scc1 L_exit
    s_setprio 3
    v_and_b32 v5, 15, v0
    v_lshrrev_b32 v6, 4, v0
    v_and_b32 v7, 3, v0
    v_lshlrev_b32 v7, 8, v7
    v_lshl_add_u32 v7, v6, 4, v7
    v_lshlrev_b32 v2, 2, v6
    v_xor_b32 v2, v2, v5
    v_lshlrev_b32 v2, 4, v2
    v_lshl_add_u32 v8, v6, 8, v2
    v_xor_b32 v9, 16, v8
    v_xor_b32 v10, 32, v8
    v_xor_b32 v11, 48, v8
    s_lshl_b32 s87, s3, 15
    s_add_u32 s87, s87, 32768
    v_and_b32 v2, 3, v5
    v_lshrrev_b32 v3, 2, v5
    v_lshl_add_u32 v2, v2, 2, v3
    v_lshlrev_b32 v2, 8, v2
    v_xor_b32 v3, v5, v6
    v_lshl_add_u32 v2, v3, 4, v2
    v_add_u32 v12, s87, v2
    v_xor_b32 v13, 64, v12
    v_xor_b32 v14, 0x80, v12
    v_xor_b32 v15, 0xc0, v12
    s_mul_i32 s89, s5, 87382
    s_lshr_b32 s89, s89, 10
    s_add_u32 s14, s5, 1
    s_mul_i32 s14, s14, 87382
    s_lshr_b32 s14, s14, 10
    s_sub_u32 s81, s14, s89
    s_lshl_b32 s81, s81, 4
    s_lshl_b32 s89, s89, 13
    s_lshl_b32 s91, s4, 24
    s_add_u32 s89, s89, s91
    s_lshl_b32 s91, s3, 13
    s_add_u32 s90, s89, s91
    s_add_u32 s91, s90, 4096
    s_mov_b32 s10, 0x3fb8aa3b
    s_mov_b32 s11, 0x3db504f3
    s_mov_b32 s12, 0x05040100
    s_mov_b32 s13, 0x07060302
    s_mov_b32 s6, 1
    s_mov_b32 s7, 1
    s_mov_b32 s8, 1
    s_mov_b32 s9, 1
    v_mov_b32 v5, 0
    s_waitcnt lgkmcnt(0)
    s_mov_b32 s44, s18
    s_mov_b32 s45, s19
    s_mov_b32 s46, 0x8000000
    s_mov_b32 s47, 0x20000
    s_mov_b32 s48, s20
    s_mov_b32 s49, s21
    s_mov_b32 s50, 0x8000000
    s_mov_b32 s51, 0x20000
    s_add_u32 m0, s87, 0
    s_nop 0
    buffer_load_dwordx4 v8, s[44:47], s90 offen offset:0 nt lds
    buffer_load_dwordx4 v9, s[44:47], s90 offen offset:1024 nt lds
    s_setprio 0
    buffer_load_dwordx4 v10, s[44:47], s90 offen offset:2048 nt lds
    buffer_load_dwordx4 v11, s[44:47], s90 offen offset:3072 nt lds
    s_add_u32 m0, s87, 4096
    s_nop 0
    buffer_load_dwordx4 v8, s[44:47], s91 offen offset:0 nt lds
    buffer_load_dwordx4 v9, s[44:47], s91 offen offset:1024 nt lds
    buffer_load_dwordx4 v10, s[44:47], s91 offen offset:2048 nt lds
    buffer_load_dwordx4 v11, s[44:47], s91 offen offset:3072 nt lds
    buffer_load_dwordx4 v[104:107], v1, s[48:51], s90 offen offset:0 nt
    buffer_load_dwordx4 v[108:111], v1, s[48:51], s90 offen offset:1024 nt
    buffer_load_dwordx4 v[112:115], v1, s[48:51], s90 offen offset:2048 nt
    buffer_load_dwordx4 v[116:119], v1, s[48:51], s90 offen offset:3072 nt
    buffer_load_dwordx4 v[120:123], v1, s[48:51], s91 offen offset:0 nt
    buffer_load_dwordx4 v[124:127], v1, s[48:51], s91 offen offset:1024 nt
    buffer_load_dwordx4 v[128:131], v1, s[48:51], s91 offen offset:2048 nt
    buffer_load_dwordx4 v[132:135], v1, s[48:51], s91 offen offset:3072 nt
    s_add_u32 s90, s90, 32768
    s_add_u32 s91, s91, 32768
    s_add_u32 m0, s87, 8192
    s_nop 0
    buffer_load_dwordx4 v8, s[44:47], s90 offen offset:0 nt lds
    buffer_load_dwordx4 v9, s[44:47], s90 offen offset:1024 nt lds
    buffer_load_dwordx4 v10, s[44:47], s90 offen offset:2048 nt lds
    buffer_load_dwordx4 v11, s[44:47], s90 offen offset:3072 nt lds
    s_add_u32 m0, s87, 12288
    s_nop 0
    buffer_load_dwordx4 v8, s[44:47], s91 offen offset:0 nt lds
    buffer_load_dwordx4 v9, s[44:47], s91 offen offset:1024 nt lds
    buffer_load_dwordx4 v10, s[44:47], s91 offen offset:2048 nt lds
    buffer_load_dwordx4 v11, s[44:47], s91 offen offset:3072 nt lds
    buffer_load_dwordx4 v[136:139], v1, s[48:51], s90 offen offset:0 nt
    buffer_load_dwordx4 v[140:143], v1, s[48:51], s90 offen offset:1024 nt
    buffer_load_dwordx4 v[144:147], v1, s[48:51], s90 offen offset:2048 nt
    buffer_load_dwordx4 v[148:151], v1, s[48:51], s90 offen offset:3072 nt
    buffer_load_dwordx4 v[152:155], v1, s[48:51], s91 offen offset:0 nt
    buffer_load_dwordx4 v[156:159], v1, s[48:51], s91 offen offset:1024 nt
    buffer_load_dwordx4 v[160:163], v1, s[48:51], s91 offen offset:2048 nt
    buffer_load_dwordx4 v[164:167], v1, s[48:51], s91 offen offset:3072 nt
    s_add_u32 s90, s90, 32768
    s_add_u32 s91, s91, 32768
    s_add_u32 m0, s87, 16384
    s_nop 0
    buffer_load_dwordx4 v8, s[44:47], s90 offen offset:0 nt lds
    buffer_load_dwordx4 v9, s[44:47], s90 offen offset:1024 nt lds
    buffer_load_dwordx4 v10, s[44:47], s90 offen offset:2048 nt lds
    buffer_load_dwordx4 v11, s[44:47], s90 offen offset:3072 nt lds
    s_add_u32 m0, s87, 20480
    s_nop 0
    buffer_load_dwordx4 v8, s[44:47], s91 offen offset:0 nt lds
    buffer_load_dwordx4 v9, s[44:47], s91 offen offset:1024 nt lds
    buffer_load_dwordx4 v10, s[44:47], s91 offen offset:2048 nt lds
    buffer_load_dwordx4 v11, s[44:47], s91 offen offset:3072 nt lds
    buffer_load_dwordx4 v[168:171], v1, s[48:51], s90 offen offset:0 nt
    buffer_load_dwordx4 v[172:175], v1, s[48:51], s90 offen offset:1024 nt
    buffer_load_dwordx4 v[176:179], v1, s[48:51], s90 offen offset:2048 nt
    buffer_load_dwordx4 v[180:183], v1, s[48:51], s90 offen offset:3072 nt
    buffer_load_dwordx4 v[184:187], v1, s[48:51], s91 offen offset:0 nt
    buffer_load_dwordx4 v[188:191], v1, s[48:51], s91 offen offset:1024 nt
    buffer_load_dwordx4 v[192:195], v1, s[48:51], s91 offen offset:2048 nt
    buffer_load_dwordx4 v[196:199], v1, s[48:51], s91 offen offset:3072 nt
    s_add_u32 s90, s90, 32768
    s_add_u32 s91, s91, 32768
    s_add_u32 m0, s87, 24576
    s_nop 0
    buffer_load_dwordx4 v8, s[44:47], s90 offen offset:0 nt lds
    buffer_load_dwordx4 v9, s[44:47], s90 offen offset:1024 nt lds
    buffer_load_dwordx4 v10, s[44:47], s90 offen offset:2048 nt lds
    buffer_load_dwordx4 v11, s[44:47], s90 offen offset:3072 nt lds
    s_add_u32 m0, s87, 28672
    s_nop 0
    buffer_load_dwordx4 v8, s[44:47], s91 offen offset:0 nt lds
    buffer_load_dwordx4 v9, s[44:47], s91 offen offset:1024 nt lds
    buffer_load_dwordx4 v10, s[44:47], s91 offen offset:2048 nt lds
    buffer_load_dwordx4 v11, s[44:47], s91 offen offset:3072 nt lds
    buffer_load_dwordx4 v[200:203], v1, s[48:51], s90 offen offset:0 nt
    buffer_load_dwordx4 v[204:207], v1, s[48:51], s90 offen offset:1024 nt
    buffer_load_dwordx4 v[208:211], v1, s[48:51], s90 offen offset:2048 nt
    buffer_load_dwordx4 v[212:215], v1, s[48:51], s90 offen offset:3072 nt
    v_mov_b32 v3, 0xff800000
    v_mov_b32 v4, 0
    v_mov_b32 v40, 0
    v_mov_b32 v41, 0
    v_mov_b32 v42, 0
    v_mov_b32 v43, 0
    v_mov_b32 v44, 0
    v_mov_b32 v45, 0
    v_mov_b32 v46, 0
    v_mov_b32 v47, 0
    v_mov_b32 v48, 0
    v_mov_b32 v49, 0
    v_mov_b32 v50, 0
    v_mov_b32 v51, 0
    v_mov_b32 v52, 0
    v_mov_b32 v53, 0
    v_mov_b32 v54, 0
    v_mov_b32 v55, 0
    v_mov_b32 v56, 0
    v_mov_b32 v57, 0
    v_mov_b32 v58, 0
    v_mov_b32 v59, 0
    v_mov_b32 v60, 0
    v_mov_b32 v61, 0
    v_mov_b32 v62, 0
    v_mov_b32 v63, 0
    v_mov_b32 v64, 0
    v_mov_b32 v65, 0
    v_mov_b32 v66, 0
    v_mov_b32 v67, 0
    v_mov_b32 v68, 0
    v_mov_b32 v69, 0
    v_mov_b32 v70, 0
    v_mov_b32 v71, 0
    ds_read_b32 v6, v5 offset:4
    s_waitcnt vmcnt(58)
    buffer_load_dwordx4 v[216:219], v1, s[48:51], s91 offen offset:0 nt
    buffer_load_dwordx4 v[220:223], v1, s[48:51], s91 offen offset:1024 nt
    s_waitcnt vmcnt(58)
    buffer_load_dwordx4 v[224:227], v1, s[48:51], s91 offen offset:2048 nt
    buffer_load_dwordx4 v[228:231], v1, s[48:51], s91 offen offset:3072 nt
    s_branch L_Pdone
L_Pdone:
    s_mov_b32 s15, 4194304
Lw_1:
    ds_read_b32 v6, v5 offset:4
    s_sub_u32 s15, s15, 1
    s_cbranch_scc1 L_end
    s_waitcnt lgkmcnt(0)
    v_readfirstlane_b32 s14, v6
    s_cmp_ge_u32 s14, 4
    s_cbranch_scc1 Lwd_2
    s_sleep 2
    s_nop 1
    s_branch Lw_1
Lwd_2:
    ds_read_b128 v[24:27], v7 offset:1536
    ds_read_b128 v[28:31], v7 offset:1600
    ds_read_b128 v[32:35], v7 offset:1664
    ds_read_b128 v[36:39], v7 offset:1728
    s_mov_b32 exec_lo, 2
    s_mov_b32 exec_hi, 0
    ds_add_rtn_u32 v2, v1, v1 offset:48
    s_mov_b64 exec, -1
L_Sloop:
    s_cmp_eq_u32 s6, 0
    s_cbranch_scc1 L_Sdone
    s_waitcnt vmcnt(56)
    ds_read_b128 v[72:75], v12 offset:0
    ds_read_b128 v[88:91], v12 offset:4096
    ds_read_b128 v[76:79], v13 offset:0
    ds_read_b128 v[92:95], v13 offset:4096
    ds_read_b128 v[80:83], v14 offset:0
    ds_read_b128 v[96:99], v14 offset:4096
    ds_read_b128 v[84:87], v15 offset:0
    ds_read_b128 v[100:103], v15 offset:4096
    s_waitcnt lgkmcnt(6)
    v_mfma_f32_16x16x32_bf16 v[16:19], v[72:75], v[24:27], 0
    v_mfma_f32_16x16x32_bf16 v[20:23], v[88:91], v[24:27], 0
    s_waitcnt lgkmcnt(4)
    v_mfma_f32_16x16x32_bf16 v[16:19], v[76:79], v[28:31], v[16:19]
    v_mfma_f32_16x16x32_bf16 v[20:23], v[92:95], v[28:31], v[20:23]
    s_waitcnt lgkmcnt(2)
    v_mfma_f32_16x16x32_bf16 v[16:19], v[80:83], v[32:35], v[16:19]
    v_mfma_f32_16x16x32_bf16 v[20:23], v[96:99], v[32:35], v[20:23]
    s_waitcnt lgkmcnt(0)
    v_mfma_f32_16x16x32_bf16 v[16:19], v[84:87], v[36:39], v[16:19]
    v_mfma_f32_16x16x32_bf16 v[20:23], v[100:103], v[36:39], v[20:23]
    v_readlane_b32 s14, v2, 1
    s_lshl_b32 s15, s14, 9
    s_add_u32 s90, s89, s15
    s_cmp_lt_u32 s14, s81
    s_cselect_b32 s6, 1, 0
    s_add_u32 s91, s90, 4096
    s_mov_b32 exec_lo, 2
    s_mov_b32 exec_hi, 0
    ds_add_rtn_u32 v2, v1, v1 offset:48
    s_mov_b64 exec, -1
    v_cvt_pk_bf16_f32 v5, v16, v17
    v_lshlrev_b32 v16, 16, v5
    v_and_b32 v17, s83, v5
    v_cvt_pk_bf16_f32 v6, v18, v19
    v_lshlrev_b32 v18, 16, v6
    v_and_b32 v19, s83, v6
    v_cvt_pk_bf16_f32 v7, v20, v21
    v_lshlrev_b32 v20, 16, v7
    v_and_b32 v21, s83, v7
    v_cvt_pk_bf16_f32 v5, v22, v23
    v_lshlrev_b32 v22, 16, v5
    v_and_b32 v23, s83, v5
    v_mul_f32 v16, s11, v16
    v_mul_f32 v17, s11, v17
    v_mul_f32 v18, s11, v18
    v_mul_f32 v19, s11, v19
    v_mul_f32 v20, s11, v20
    v_mul_f32 v21, s11, v21
    v_mul_f32 v22, s11, v22
    v_mul_f32 v23, s11, v23
    v_cvt_pk_bf16_f32 v5, v16, v17
    v_lshlrev_b32 v16, 16, v5
    v_and_b32 v17, s83, v5
    v_cvt_pk_bf16_f32 v6, v18, v19
    v_lshlrev_b32 v18, 16, v6
    v_and_b32 v19, s83, v6
    v_cvt_pk_bf16_f32 v7, v20, v21
    v_lshlrev_b32 v20, 16, v7
    v_and_b32 v21, s83, v7
    v_cvt_pk_bf16_f32 v5, v22, v23
    v_lshlrev_b32 v22, 16, v5
    v_and_b32 v23, s83, v5
    v_max3_f32 v5, v16, v17, v18
    v_max3_f32 v6, v19, v20, v21
    v_max3_f32 v5, v5, v22, v23
    v_max_f32 v5, v5, v6
    v_mul_f32 v5, s10, v5
    v_cmp_gt_f32 vcc, v5, v3
    s_cbranch_vccz Lnomax_5
    v_mov_b32 v6, v5
    s_nop 1
    v_permlane16_swap_b32 v5, v6
    v_max_f32 v5, v5, v6
    v_mov_b32 v6, v5
    s_nop 1
    v_permlane32_swap_b32 v5, v6
    v_max_f32 v5, v5, v6
    v_ceil_f32 v5, v5
    v_max_f32 v5, v5, v3
    v_sub_f32 v6, v3, v5
    v_exp_f32 v6, v6
    v_mov_b32 v3, v5
    v_mul_f32 v4, v4, v6
    v_mul_f32 v40, v40, v6
    v_mul_f32 v41, v41, v6
    v_mul_f32 v42, v42, v6
    v_mul_f32 v43, v43, v6
    v_mul_f32 v44, v44, v6
    v_mul_f32 v45, v45, v6
    v_mul_f32 v46, v46, v6
    v_mul_f32 v47, v47, v6
    v_mul_f32 v48, v48, v6
    v_mul_f32 v49, v49, v6
    v_mul_f32 v50, v50, v6
    v_mul_f32 v51, v51, v6
    v_mul_f32 v52, v52, v6
    v_mul_f32 v53, v53, v6
    v_mul_f32 v54, v54, v6
    v_mul_f32 v55, v55, v6
    v_mul_f32 v56, v56, v6
    v_mul_f32 v57, v57, v6
    v_mul_f32 v58, v58, v6
    v_mul_f32 v59, v59, v6
    v_mul_f32 v60, v60, v6
    v_mul_f32 v61, v61, v6
    v_mul_f32 v62, v62, v6
    v_mul_f32 v63, v63, v6
    v_mul_f32 v64, v64, v6
    v_mul_f32 v65, v65, v6
    v_mul_f32 v66, v66, v6
    v_mul_f32 v67, v67, v6
    v_mul_f32 v68, v68, v6
    v_mul_f32 v69, v69, v6
    v_mul_f32 v70, v70, v6
    v_mul_f32 v71, v71, v6
Lnomax_5:
    v_fma_f32 v16, v16, s10, -v3
    v_fma_f32 v17, v17, s10, -v3
    v_fma_f32 v18, v18, s10, -v3
    v_fma_f32 v19, v19, s10, -v3
    v_fma_f32 v20, v20, s10, -v3
    v_fma_f32 v21, v21, s10, -v3
    v_fma_f32 v22, v22, s10, -v3
    v_fma_f32 v23, v23, s10, -v3
    v_exp_f32 v16, v16
    v_exp_f32 v17, v17
    v_exp_f32 v18, v18
    v_exp_f32 v19, v19
    v_exp_f32 v20, v20
    v_exp_f32 v21, v21
    v_exp_f32 v22, v22
    v_exp_f32 v23, v23
    v_add_f32 v5, v16, v17
    v_add_f32 v6, v18, v19
    v_add_f32 v7, v20, v21
    v_add_f32 v4, v4, v22
    v_add_f32 v5, v5, v6
    v_add_f32 v7, v7, v23
    v_add_f32 v4, v4, v5
    v_add_f32 v4, v4, v7
    v_cvt_pk_bf16_f32 v16, v16, v17
    v_cvt_pk_bf16_f32 v17, v18, v19
    v_cvt_pk_bf16_f32 v18, v20, v21
    v_cvt_pk_bf16_f32 v19, v22, v23
    s_waitcnt vmcnt(48)
    v_perm_b32 v72, v108, v104, s12
    v_perm_b32 v73, v116, v112, s12
    v_perm_b32 v74, v124, v120, s12
    v_perm_b32 v75, v132, v128, s12
    v_perm_b32 v76, v108, v104, s13
    v_perm_b32 v77, v116, v112, s13
    v_perm_b32 v78, v124, v120, s13
    v_perm_b32 v79, v132, v128, s13
    v_mfma_f32_16x16x32_bf16 v[40:43], v[72:75], v[16:19], v[40:43]
    v_perm_b32 v80, v109, v105, s12
    v_perm_b32 v81, v117, v113, s12
    v_perm_b32 v82, v125, v121, s12
    v_perm_b32 v83, v133, v129, s12
    v_mfma_f32_16x16x32_bf16 v[44:47], v[76:79], v[16:19], v[44:47]
    v_perm_b32 v84, v109, v105, s13
    v_perm_b32 v85, v117, v113, s13
    v_perm_b32 v86, v125, v121, s13
    v_perm_b32 v87, v133, v129, s13
    v_mfma_f32_16x16x32_bf16 v[48:51], v[80:83], v[16:19], v[48:51]
    v_perm_b32 v88, v110, v106, s12
    v_perm_b32 v89, v118, v114, s12
    v_perm_b32 v90, v126, v122, s12
    v_perm_b32 v91, v134, v130, s12
    v_mfma_f32_16x16x32_bf16 v[52:55], v[84:87], v[16:19], v[52:55]
    v_perm_b32 v92, v110, v106, s13
    v_perm_b32 v93, v118, v114, s13
    v_perm_b32 v94, v126, v122, s13
    v_perm_b32 v95, v134, v130, s13
    v_mfma_f32_16x16x32_bf16 v[56:59], v[88:91], v[16:19], v[56:59]
    v_perm_b32 v96, v111, v107, s12
    v_perm_b32 v97, v119, v115, s12
    v_perm_b32 v98, v127, v123, s12
    v_perm_b32 v99, v135, v131, s12
    v_mfma_f32_16x16x32_bf16 v[60:63], v[92:95], v[16:19], v[60:63]
    v_perm_b32 v100, v111, v107, s13
    v_perm_b32 v101, v119, v115, s13
    v_perm_b32 v102, v127, v123, s13
    v_perm_b32 v103, v135, v131, s13
    v_mfma_f32_16x16x32_bf16 v[64:67], v[96:99], v[16:19], v[64:67]
    s_nop 0
    v_mfma_f32_16x16x32_bf16 v[68:71], v[100:103], v[16:19], v[68:71]
    s_cmp_eq_u32 s6, 0
    s_cbranch_scc0 Lti_3
    s_waitcnt vmcnt(0)
    s_branch Ltk_4
Lti_3:
    s_add_u32 m0, s87, 0
    s_nop 0
    buffer_load_dwordx4 v8, s[44:47], s90 offen offset:0 nt lds
    buffer_load_dwordx4 v9, s[44:47], s90 offen offset:1024 nt lds
    buffer_load_dwordx4 v10, s[44:47], s90 offen offset:2048 nt lds
    buffer_load_dwordx4 v11, s[44:47], s90 offen offset:3072 nt lds
    s_add_u32 m0, s87, 4096
    s_nop 0
    buffer_load_dwordx4 v8, s[44:47], s91 offen offset:0 nt lds
    buffer_load_dwordx4 v9, s[44:47], s91 offen offset:1024 nt lds
    buffer_load_dwordx4 v10, s[44:47], s91 offen offset:2048 nt lds
    buffer_load_dwordx4 v11, s[44:47], s91 offen offset:3072 nt lds
    buffer_load_dwordx4 v[104:107], v1, s[48:51], s90 offen offset:0 nt
    buffer_load_dwordx4 v[108:111], v1, s[48:51], s90 offen offset:1024 nt
    buffer_load_dwordx4 v[112:115], v1, s[48:51], s90 offen offset:2048 nt
    buffer_load_dwordx4 v[116:119], v1, s[48:51], s90 offen offset:3072 nt
    buffer_load_dwordx4 v[120:123], v1, s[48:51], s91 offen offset:0 nt
    buffer_load_dwordx4 v[124:127], v1, s[48:51], s91 offen offset:1024 nt
    buffer_load_dwordx4 v[128:131], v1, s[48:51], s91 offen offset:2048 nt
    buffer_load_dwordx4 v[132:135], v1, s[48:51], s91 offen offset:3072 nt
Ltk_4:
    s_cmp_eq_u32 s7, 0
    s_cbranch_scc1 L_Sdone
    s_waitcnt vmcnt(56)
    ds_read_b128 v[72:75], v12 offset:8192
    ds_read_b128 v[88:91], v12 offset:12288
    ds_read_b128 v[76:79], v13 offset:8192
    ds_read_b128 v[92:95], v13 offset:12288
    ds_read_b128 v[80:83], v14 offset:8192
    ds_read_b128 v[96:99], v14 offset:12288
    ds_read_b128 v[84:87], v15 offset:8192
    ds_read_b128 v[100:103], v15 offset:12288
    s_waitcnt lgkmcnt(6)
    v_mfma_f32_16x16x32_bf16 v[16:19], v[72:75], v[24:27], 0
    v_mfma_f32_16x16x32_bf16 v[20:23], v[88:91], v[24:27], 0
    s_waitcnt lgkmcnt(4)
    v_mfma_f32_16x16x32_bf16 v[16:19], v[76:79], v[28:31], v[16:19]
    v_mfma_f32_16x16x32_bf16 v[20:23], v[92:95], v[28:31], v[20:23]
    s_waitcnt lgkmcnt(2)
    v_mfma_f32_16x16x32_bf16 v[16:19], v[80:83], v[32:35], v[16:19]
    v_mfma_f32_16x16x32_bf16 v[20:23], v[96:99], v[32:35], v[20:23]
    s_waitcnt lgkmcnt(0)
    v_mfma_f32_16x16x32_bf16 v[16:19], v[84:87], v[36:39], v[16:19]
    v_mfma_f32_16x16x32_bf16 v[20:23], v[100:103], v[36:39], v[20:23]
    v_readlane_b32 s14, v2, 1
    s_lshl_b32 s15, s14, 9
    s_add_u32 s90, s89, s15
    s_cmp_lt_u32 s14, s81
    s_cselect_b32 s7, 1, 0
    s_add_u32 s91, s90, 4096
    s_mov_b32 exec_lo, 2
    s_mov_b32 exec_hi, 0
    ds_add_rtn_u32 v2, v1, v1 offset:48
    s_mov_b64 exec, -1
    v_cvt_pk_bf16_f32 v5, v16, v17
    v_lshlrev_b32 v16, 16, v5
    v_and_b32 v17, s83, v5
    v_cvt_pk_bf16_f32 v6, v18, v19
    v_lshlrev_b32 v18, 16, v6
    v_and_b32 v19, s83, v6
    v_cvt_pk_bf16_f32 v7, v20, v21
    v_lshlrev_b32 v20, 16, v7
    v_and_b32 v21, s83, v7
    v_cvt_pk_bf16_f32 v5, v22, v23
    v_lshlrev_b32 v22, 16, v5
    v_and_b32 v23, s83, v5
    v_mul_f32 v16, s11, v16
    v_mul_f32 v17, s11, v17
    v_mul_f32 v18, s11, v18
    v_mul_f32 v19, s11, v19
    v_mul_f32 v20, s11, v20
    v_mul_f32 v21, s11, v21
    v_mul_f32 v22, s11, v22
    v_mul_f32 v23, s11, v23
    v_cvt_pk_bf16_f32 v5, v16, v17
    v_lshlrev_b32 v16, 16, v5
    v_and_b32 v17, s83, v5
    v_cvt_pk_bf16_f32 v6, v18, v19
    v_lshlrev_b32 v18, 16, v6
    v_and_b32 v19, s83, v6
    v_cvt_pk_bf16_f32 v7, v20, v21
    v_lshlrev_b32 v20, 16, v7
    v_and_b32 v21, s83, v7
    v_cvt_pk_bf16_f32 v5, v22, v23
    v_lshlrev_b32 v22, 16, v5
    v_and_b32 v23, s83, v5
    v_max3_f32 v5, v16, v17, v18
    v_max3_f32 v6, v19, v20, v21
    v_max3_f32 v5, v5, v22, v23
    v_max_f32 v5, v5, v6
    v_mul_f32 v5, s10, v5
    v_cmp_gt_f32 vcc, v5, v3
    s_cbranch_vccz Lnomax_8
    v_mov_b32 v6, v5
    s_nop 1
    v_permlane16_swap_b32 v5, v6
    v_max_f32 v5, v5, v6
    v_mov_b32 v6, v5
    s_nop 1
    v_permlane32_swap_b32 v5, v6
    v_max_f32 v5, v5, v6
    v_ceil_f32 v5, v5
    v_max_f32 v5, v5, v3
    v_sub_f32 v6, v3, v5
    v_exp_f32 v6, v6
    v_mov_b32 v3, v5
    v_mul_f32 v4, v4, v6
    v_mul_f32 v40, v40, v6
    v_mul_f32 v41, v41, v6
    v_mul_f32 v42, v42, v6
    v_mul_f32 v43, v43, v6
    v_mul_f32 v44, v44, v6
    v_mul_f32 v45, v45, v6
    v_mul_f32 v46, v46, v6
    v_mul_f32 v47, v47, v6
    v_mul_f32 v48, v48, v6
    v_mul_f32 v49, v49, v6
    v_mul_f32 v50, v50, v6
    v_mul_f32 v51, v51, v6
    v_mul_f32 v52, v52, v6
    v_mul_f32 v53, v53, v6
    v_mul_f32 v54, v54, v6
    v_mul_f32 v55, v55, v6
    v_mul_f32 v56, v56, v6
    v_mul_f32 v57, v57, v6
    v_mul_f32 v58, v58, v6
    v_mul_f32 v59, v59, v6
    v_mul_f32 v60, v60, v6
    v_mul_f32 v61, v61, v6
    v_mul_f32 v62, v62, v6
    v_mul_f32 v63, v63, v6
    v_mul_f32 v64, v64, v6
    v_mul_f32 v65, v65, v6
    v_mul_f32 v66, v66, v6
    v_mul_f32 v67, v67, v6
    v_mul_f32 v68, v68, v6
    v_mul_f32 v69, v69, v6
    v_mul_f32 v70, v70, v6
    v_mul_f32 v71, v71, v6
Lnomax_8:
    v_fma_f32 v16, v16, s10, -v3
    v_fma_f32 v17, v17, s10, -v3
    v_fma_f32 v18, v18, s10, -v3
    v_fma_f32 v19, v19, s10, -v3
    v_fma_f32 v20, v20, s10, -v3
    v_fma_f32 v21, v21, s10, -v3
    v_fma_f32 v22, v22, s10, -v3
    v_fma_f32 v23, v23, s10, -v3
    v_exp_f32 v16, v16
    v_exp_f32 v17, v17
    v_exp_f32 v18, v18
    v_exp_f32 v19, v19
    v_exp_f32 v20, v20
    v_exp_f32 v21, v21
    v_exp_f32 v22, v22
    v_exp_f32 v23, v23
    v_add_f32 v5, v16, v17
    v_add_f32 v6, v18, v19
    v_add_f32 v7, v20, v21
    v_add_f32 v4, v4, v22
    v_add_f32 v5, v5, v6
    v_add_f32 v7, v7, v23
    v_add_f32 v4, v4, v5
    v_add_f32 v4, v4, v7
    v_cvt_pk_bf16_f32 v16, v16, v17
    v_cvt_pk_bf16_f32 v17, v18, v19
    v_cvt_pk_bf16_f32 v18, v20, v21
    v_cvt_pk_bf16_f32 v19, v22, v23
    s_waitcnt vmcnt(48)
    v_perm_b32 v72, v140, v136, s12
    v_perm_b32 v73, v148, v144, s12
    v_perm_b32 v74, v156, v152, s12
    v_perm_b32 v75, v164, v160, s12
    v_perm_b32 v76, v140, v136, s13
    v_perm_b32 v77, v148, v144, s13
    v_perm_b32 v78, v156, v152, s13
    v_perm_b32 v79, v164, v160, s13
    v_mfma_f32_16x16x32_bf16 v[40:43], v[72:75], v[16:19], v[40:43]
    v_perm_b32 v80, v141, v137, s12
    v_perm_b32 v81, v149, v145, s12
    v_perm_b32 v82, v157, v153, s12
    v_perm_b32 v83, v165, v161, s12
    v_mfma_f32_16x16x32_bf16 v[44:47], v[76:79], v[16:19], v[44:47]
    v_perm_b32 v84, v141, v137, s13
    v_perm_b32 v85, v149, v145, s13
    v_perm_b32 v86, v157, v153, s13
    v_perm_b32 v87, v165, v161, s13
    v_mfma_f32_16x16x32_bf16 v[48:51], v[80:83], v[16:19], v[48:51]
    v_perm_b32 v88, v142, v138, s12
    v_perm_b32 v89, v150, v146, s12
    v_perm_b32 v90, v158, v154, s12
    v_perm_b32 v91, v166, v162, s12
    v_mfma_f32_16x16x32_bf16 v[52:55], v[84:87], v[16:19], v[52:55]
    v_perm_b32 v92, v142, v138, s13
    v_perm_b32 v93, v150, v146, s13
    v_perm_b32 v94, v158, v154, s13
    v_perm_b32 v95, v166, v162, s13
    v_mfma_f32_16x16x32_bf16 v[56:59], v[88:91], v[16:19], v[56:59]
    v_perm_b32 v96, v143, v139, s12
    v_perm_b32 v97, v151, v147, s12
    v_perm_b32 v98, v159, v155, s12
    v_perm_b32 v99, v167, v163, s12
    v_mfma_f32_16x16x32_bf16 v[60:63], v[92:95], v[16:19], v[60:63]
    v_perm_b32 v100, v143, v139, s13
    v_perm_b32 v101, v151, v147, s13
    v_perm_b32 v102, v159, v155, s13
    v_perm_b32 v103, v167, v163, s13
    v_mfma_f32_16x16x32_bf16 v[64:67], v[96:99], v[16:19], v[64:67]
    s_nop 0
    v_mfma_f32_16x16x32_bf16 v[68:71], v[100:103], v[16:19], v[68:71]
    s_cmp_eq_u32 s7, 0
    s_cbranch_scc0 Lti_6
    s_waitcnt vmcnt(0)
    s_branch Ltk_7
Lti_6:
    s_add_u32 m0, s87, 8192
    s_nop 0
    buffer_load_dwordx4 v8, s[44:47], s90 offen offset:0 nt lds
    buffer_load_dwordx4 v9, s[44:47], s90 offen offset:1024 nt lds
    buffer_load_dwordx4 v10, s[44:47], s90 offen offset:2048 nt lds
    buffer_load_dwordx4 v11, s[44:47], s90 offen offset:3072 nt lds
    s_add_u32 m0, s87, 12288
    s_nop 0
    buffer_load_dwordx4 v8, s[44:47], s91 offen offset:0 nt lds
    buffer_load_dwordx4 v9, s[44:47], s91 offen offset:1024 nt lds
    buffer_load_dwordx4 v10, s[44:47], s91 offen offset:2048 nt lds
    buffer_load_dwordx4 v11, s[44:47], s91 offen offset:3072 nt lds
    buffer_load_dwordx4 v[136:139], v1, s[48:51], s90 offen offset:0 nt
    buffer_load_dwordx4 v[140:143], v1, s[48:51], s90 offen offset:1024 nt
    buffer_load_dwordx4 v[144:147], v1, s[48:51], s90 offen offset:2048 nt
    buffer_load_dwordx4 v[148:151], v1, s[48:51], s90 offen offset:3072 nt
    buffer_load_dwordx4 v[152:155], v1, s[48:51], s91 offen offset:0 nt
    buffer_load_dwordx4 v[156:159], v1, s[48:51], s91 offen offset:1024 nt
    buffer_load_dwordx4 v[160:163], v1, s[48:51], s91 offen offset:2048 nt
    buffer_load_dwordx4 v[164:167], v1, s[48:51], s91 offen offset:3072 nt
Ltk_7:
    s_cmp_eq_u32 s8, 0
    s_cbranch_scc1 L_Sdone
    s_waitcnt vmcnt(56)
    ds_read_b128 v[72:75], v12 offset:16384
    ds_read_b128 v[88:91], v12 offset:20480
    ds_read_b128 v[76:79], v13 offset:16384
    ds_read_b128 v[92:95], v13 offset:20480
    ds_read_b128 v[80:83], v14 offset:16384
    ds_read_b128 v[96:99], v14 offset:20480
    ds_read_b128 v[84:87], v15 offset:16384
    ds_read_b128 v[100:103], v15 offset:20480
    s_waitcnt lgkmcnt(6)
    v_mfma_f32_16x16x32_bf16 v[16:19], v[72:75], v[24:27], 0
    v_mfma_f32_16x16x32_bf16 v[20:23], v[88:91], v[24:27], 0
    s_waitcnt lgkmcnt(4)
    v_mfma_f32_16x16x32_bf16 v[16:19], v[76:79], v[28:31], v[16:19]
    v_mfma_f32_16x16x32_bf16 v[20:23], v[92:95], v[28:31], v[20:23]
    s_waitcnt lgkmcnt(2)
    v_mfma_f32_16x16x32_bf16 v[16:19], v[80:83], v[32:35], v[16:19]
    v_mfma_f32_16x16x32_bf16 v[20:23], v[96:99], v[32:35], v[20:23]
    s_waitcnt lgkmcnt(0)
    v_mfma_f32_16x16x32_bf16 v[16:19], v[84:87], v[36:39], v[16:19]
    v_mfma_f32_16x16x32_bf16 v[20:23], v[100:103], v[36:39], v[20:23]
    v_readlane_b32 s14, v2, 1
    s_lshl_b32 s15, s14, 9
    s_add_u32 s90, s89, s15
    s_cmp_lt_u32 s14, s81
    s_cselect_b32 s8, 1, 0
    s_add_u32 s91, s90, 4096
    s_mov_b32 exec_lo, 2
    s_mov_b32 exec_hi, 0
    ds_add_rtn_u32 v2, v1, v1 offset:48
    s_mov_b64 exec, -1
    v_cvt_pk_bf16_f32 v5, v16, v17
    v_lshlrev_b32 v16, 16, v5
    v_and_b32 v17, s83, v5
    v_cvt_pk_bf16_f32 v6, v18, v19
    v_lshlrev_b32 v18, 16, v6
    v_and_b32 v19, s83, v6
    v_cvt_pk_bf16_f32 v7, v20, v21
    v_lshlrev_b32 v20, 16, v7
    v_and_b32 v21, s83, v7
    v_cvt_pk_bf16_f32 v5, v22, v23
    v_lshlrev_b32 v22, 16, v5
    v_and_b32 v23, s83, v5
    v_mul_f32 v16, s11, v16
    v_mul_f32 v17, s11, v17
    v_mul_f32 v18, s11, v18
    v_mul_f32 v19, s11, v19
    v_mul_f32 v20, s11, v20
    v_mul_f32 v21, s11, v21
    v_mul_f32 v22, s11, v22
    v_mul_f32 v23, s11, v23
    v_cvt_pk_bf16_f32 v5, v16, v17
    v_lshlrev_b32 v16, 16, v5
    v_and_b32 v17, s83, v5
    v_cvt_pk_bf16_f32 v6, v18, v19
    v_lshlrev_b32 v18, 16, v6
    v_and_b32 v19, s83, v6
    v_cvt_pk_bf16_f32 v7, v20, v21
    v_lshlrev_b32 v20, 16, v7
    v_and_b32 v21, s83, v7
    v_cvt_pk_bf16_f32 v5, v22, v23
    v_lshlrev_b32 v22, 16, v5
    v_and_b32 v23, s83, v5
    v_max3_f32 v5, v16, v17, v18
    v_max3_f32 v6, v19, v20, v21
    v_max3_f32 v5, v5, v22, v23
    v_max_f32 v5, v5, v6
    v_mul_f32 v5, s10, v5
    v_cmp_gt_f32 vcc, v5, v3
    s_cbranch_vccz Lnomax_11
    v_mov_b32 v6, v5
    s_nop 1
    v_permlane16_swap_b32 v5, v6
    v_max_f32 v5, v5, v6
    v_mov_b32 v6, v5
    s_nop 1
    v_permlane32_swap_b32 v5, v6
    v_max_f32 v5, v5, v6
    v_ceil_f32 v5, v5
    v_max_f32 v5, v5, v3
    v_sub_f32 v6, v3, v5
    v_exp_f32 v6, v6
    v_mov_b32 v3, v5
    v_mul_f32 v4, v4, v6
    v_mul_f32 v40, v40, v6
    v_mul_f32 v41, v41, v6
    v_mul_f32 v42, v42, v6
    v_mul_f32 v43, v43, v6
    v_mul_f32 v44, v44, v6
    v_mul_f32 v45, v45, v6
    v_mul_f32 v46, v46, v6
    v_mul_f32 v47, v47, v6
    v_mul_f32 v48, v48, v6
    v_mul_f32 v49, v49, v6
    v_mul_f32 v50, v50, v6
    v_mul_f32 v51, v51, v6
    v_mul_f32 v52, v52, v6
    v_mul_f32 v53, v53, v6
    v_mul_f32 v54, v54, v6
    v_mul_f32 v55, v55, v6
    v_mul_f32 v56, v56, v6
    v_mul_f32 v57, v57, v6
    v_mul_f32 v58, v58, v6
    v_mul_f32 v59, v59, v6
    v_mul_f32 v60, v60, v6
    v_mul_f32 v61, v61, v6
    v_mul_f32 v62, v62, v6
    v_mul_f32 v63, v63, v6
    v_mul_f32 v64, v64, v6
    v_mul_f32 v65, v65, v6
    v_mul_f32 v66, v66, v6
    v_mul_f32 v67, v67, v6
    v_mul_f32 v68, v68, v6
    v_mul_f32 v69, v69, v6
    v_mul_f32 v70, v70, v6
    v_mul_f32 v71, v71, v6
Lnomax_11:
    v_fma_f32 v16, v16, s10, -v3
    v_fma_f32 v17, v17, s10, -v3
    v_fma_f32 v18, v18, s10, -v3
    v_fma_f32 v19, v19, s10, -v3
    v_fma_f32 v20, v20, s10, -v3
    v_fma_f32 v21, v21, s10, -v3
    v_fma_f32 v22, v22, s10, -v3
    v_fma_f32 v23, v23, s10, -v3
    v_exp_f32 v16, v16
    v_exp_f32 v17, v17
    v_exp_f32 v18, v18
    v_exp_f32 v19, v19
    v_exp_f32 v20, v20
    v_exp_f32 v21, v21
    v_exp_f32 v22, v22
    v_exp_f32 v23, v23
    v_add_f32 v5, v16, v17
    v_add_f32 v6, v18, v19
    v_add_f32 v7, v20, v21
    v_add_f32 v4, v4, v22
    v_add_f32 v5, v5, v6
    v_add_f32 v7, v7, v23
    v_add_f32 v4, v4, v5
    v_add_f32 v4, v4, v7
    v_cvt_pk_bf16_f32 v16, v16, v17
    v_cvt_pk_bf16_f32 v17, v18, v19
    v_cvt_pk_bf16_f32 v18, v20, v21
    v_cvt_pk_bf16_f32 v19, v22, v23
    s_waitcnt vmcnt(48)
    v_perm_b32 v72, v172, v168, s12
    v_perm_b32 v73, v180, v176, s12
    v_perm_b32 v74, v188, v184, s12
    v_perm_b32 v75, v196, v192, s12
    v_perm_b32 v76, v172, v168, s13
    v_perm_b32 v77, v180, v176, s13
    v_perm_b32 v78, v188, v184, s13
    v_perm_b32 v79, v196, v192, s13
    v_mfma_f32_16x16x32_bf16 v[40:43], v[72:75], v[16:19], v[40:43]
    v_perm_b32 v80, v173, v169, s12
    v_perm_b32 v81, v181, v177, s12
    v_perm_b32 v82, v189, v185, s12
    v_perm_b32 v83, v197, v193, s12
    v_mfma_f32_16x16x32_bf16 v[44:47], v[76:79], v[16:19], v[44:47]
    v_perm_b32 v84, v173, v169, s13
    v_perm_b32 v85, v181, v177, s13
    v_perm_b32 v86, v189, v185, s13
    v_perm_b32 v87, v197, v193, s13
    v_mfma_f32_16x16x32_bf16 v[48:51], v[80:83], v[16:19], v[48:51]
    v_perm_b32 v88, v174, v170, s12
    v_perm_b32 v89, v182, v178, s12
    v_perm_b32 v90, v190, v186, s12
    v_perm_b32 v91, v198, v194, s12
    v_mfma_f32_16x16x32_bf16 v[52:55], v[84:87], v[16:19], v[52:55]
    v_perm_b32 v92, v174, v170, s13
    v_perm_b32 v93, v182, v178, s13
    v_perm_b32 v94, v190, v186, s13
    v_perm_b32 v95, v198, v194, s13
    v_mfma_f32_16x16x32_bf16 v[56:59], v[88:91], v[16:19], v[56:59]
    v_perm_b32 v96, v175, v171, s12
    v_perm_b32 v97, v183, v179, s12
    v_perm_b32 v98, v191, v187, s12
    v_perm_b32 v99, v199, v195, s12
    v_mfma_f32_16x16x32_bf16 v[60:63], v[92:95], v[16:19], v[60:63]
    v_perm_b32 v100, v175, v171, s13
    v_perm_b32 v101, v183, v179, s13
    v_perm_b32 v102, v191, v187, s13
    v_perm_b32 v103, v199, v195, s13
    v_mfma_f32_16x16x32_bf16 v[64:67], v[96:99], v[16:19], v[64:67]
    s_nop 0
    v_mfma_f32_16x16x32_bf16 v[68:71], v[100:103], v[16:19], v[68:71]
    s_cmp_eq_u32 s8, 0
    s_cbranch_scc0 Lti_9
    s_waitcnt vmcnt(0)
    s_branch Ltk_10
Lti_9:
    s_add_u32 m0, s87, 16384
    s_nop 0
    buffer_load_dwordx4 v8, s[44:47], s90 offen offset:0 nt lds
    buffer_load_dwordx4 v9, s[44:47], s90 offen offset:1024 nt lds
    buffer_load_dwordx4 v10, s[44:47], s90 offen offset:2048 nt lds
    buffer_load_dwordx4 v11, s[44:47], s90 offen offset:3072 nt lds
    s_add_u32 m0, s87, 20480
    s_nop 0
    buffer_load_dwordx4 v8, s[44:47], s91 offen offset:0 nt lds
    buffer_load_dwordx4 v9, s[44:47], s91 offen offset:1024 nt lds
    buffer_load_dwordx4 v10, s[44:47], s91 offen offset:2048 nt lds
    buffer_load_dwordx4 v11, s[44:47], s91 offen offset:3072 nt lds
    buffer_load_dwordx4 v[168:171], v1, s[48:51], s90 offen offset:0 nt
    buffer_load_dwordx4 v[172:175], v1, s[48:51], s90 offen offset:1024 nt
    buffer_load_dwordx4 v[176:179], v1, s[48:51], s90 offen offset:2048 nt
    buffer_load_dwordx4 v[180:183], v1, s[48:51], s90 offen offset:3072 nt
    buffer_load_dwordx4 v[184:187], v1, s[48:51], s91 offen offset:0 nt
    buffer_load_dwordx4 v[188:191], v1, s[48:51], s91 offen offset:1024 nt
    buffer_load_dwordx4 v[192:195], v1, s[48:51], s91 offen offset:2048 nt
    buffer_load_dwordx4 v[196:199], v1, s[48:51], s91 offen offset:3072 nt
Ltk_10:
    s_cmp_eq_u32 s9, 0
    s_cbranch_scc1 L_Sdone
    s_waitcnt vmcnt(56)
    ds_read_b128 v[72:75], v12 offset:24576
    ds_read_b128 v[88:91], v12 offset:28672
    ds_read_b128 v[76:79], v13 offset:24576
    ds_read_b128 v[92:95], v13 offset:28672
    ds_read_b128 v[80:83], v14 offset:24576
    ds_read_b128 v[96:99], v14 offset:28672
    ds_read_b128 v[84:87], v15 offset:24576
    ds_read_b128 v[100:103], v15 offset:28672
    s_waitcnt lgkmcnt(6)
    v_mfma_f32_16x16x32_bf16 v[16:19], v[72:75], v[24:27], 0
    v_mfma_f32_16x16x32_bf16 v[20:23], v[88:91], v[24:27], 0
    s_waitcnt lgkmcnt(4)
    v_mfma_f32_16x16x32_bf16 v[16:19], v[76:79], v[28:31], v[16:19]
    v_mfma_f32_16x16x32_bf16 v[20:23], v[92:95], v[28:31], v[20:23]
    s_waitcnt lgkmcnt(2)
    v_mfma_f32_16x16x32_bf16 v[16:19], v[80:83], v[32:35], v[16:19]
    v_mfma_f32_16x16x32_bf16 v[20:23], v[96:99], v[32:35], v[20:23]
    s_waitcnt lgkmcnt(0)
    v_mfma_f32_16x16x32_bf16 v[16:19], v[84:87], v[36:39], v[16:19]
    v_mfma_f32_16x16x32_bf16 v[20:23], v[100:103], v[36:39], v[20:23]
    v_readlane_b32 s14, v2, 1
    s_lshl_b32 s15, s14, 9
    s_add_u32 s90, s89, s15
    s_cmp_lt_u32 s14, s81
    s_cselect_b32 s9, 1, 0
    s_add_u32 s91, s90, 4096
    s_mov_b32 exec_lo, 2
    s_mov_b32 exec_hi, 0
    ds_add_rtn_u32 v2, v1, v1 offset:48
    s_mov_b64 exec, -1
    v_cvt_pk_bf16_f32 v5, v16, v17
    v_lshlrev_b32 v16, 16, v5
    v_and_b32 v17, s83, v5
    v_cvt_pk_bf16_f32 v6, v18, v19
    v_lshlrev_b32 v18, 16, v6
    v_and_b32 v19, s83, v6
    v_cvt_pk_bf16_f32 v7, v20, v21
    v_lshlrev_b32 v20, 16, v7
    v_and_b32 v21, s83, v7
    v_cvt_pk_bf16_f32 v5, v22, v23
    v_lshlrev_b32 v22, 16, v5
    v_and_b32 v23, s83, v5
    v_mul_f32 v16, s11, v16
    v_mul_f32 v17, s11, v17
    v_mul_f32 v18, s11, v18
    v_mul_f32 v19, s11, v19
    v_mul_f32 v20, s11, v20
    v_mul_f32 v21, s11, v21
    v_mul_f32 v22, s11, v22
    v_mul_f32 v23, s11, v23
    v_cvt_pk_bf16_f32 v5, v16, v17
    v_lshlrev_b32 v16, 16, v5
    v_and_b32 v17, s83, v5
    v_cvt_pk_bf16_f32 v6, v18, v19
    v_lshlrev_b32 v18, 16, v6
    v_and_b32 v19, s83, v6
    v_cvt_pk_bf16_f32 v7, v20, v21
    v_lshlrev_b32 v20, 16, v7
    v_and_b32 v21, s83, v7
    v_cvt_pk_bf16_f32 v5, v22, v23
    v_lshlrev_b32 v22, 16, v5
    v_and_b32 v23, s83, v5
    v_max3_f32 v5, v16, v17, v18
    v_max3_f32 v6, v19, v20, v21
    v_max3_f32 v5, v5, v22, v23
    v_max_f32 v5, v5, v6
    v_mul_f32 v5, s10, v5
    v_cmp_gt_f32 vcc, v5, v3
    s_cbranch_vccz Lnomax_14
    v_mov_b32 v6, v5
    s_nop 1
    v_permlane16_swap_b32 v5, v6
    v_max_f32 v5, v5, v6
    v_mov_b32 v6, v5
    s_nop 1
    v_permlane32_swap_b32 v5, v6
    v_max_f32 v5, v5, v6
    v_ceil_f32 v5, v5
    v_max_f32 v5, v5, v3
    v_sub_f32 v6, v3, v5
    v_exp_f32 v6, v6
    v_mov_b32 v3, v5
    v_mul_f32 v4, v4, v6
    v_mul_f32 v40, v40, v6
    v_mul_f32 v41, v41, v6
    v_mul_f32 v42, v42, v6
    v_mul_f32 v43, v43, v6
    v_mul_f32 v44, v44, v6
    v_mul_f32 v45, v45, v6
    v_mul_f32 v46, v46, v6
    v_mul_f32 v47, v47, v6
    v_mul_f32 v48, v48, v6
    v_mul_f32 v49, v49, v6
    v_mul_f32 v50, v50, v6
    v_mul_f32 v51, v51, v6
    v_mul_f32 v52, v52, v6
    v_mul_f32 v53, v53, v6
    v_mul_f32 v54, v54, v6
    v_mul_f32 v55, v55, v6
    v_mul_f32 v56, v56, v6
    v_mul_f32 v57, v57, v6
    v_mul_f32 v58, v58, v6
    v_mul_f32 v59, v59, v6
    v_mul_f32 v60, v60, v6
    v_mul_f32 v61, v61, v6
    v_mul_f32 v62, v62, v6
    v_mul_f32 v63, v63, v6
    v_mul_f32 v64, v64, v6
    v_mul_f32 v65, v65, v6
    v_mul_f32 v66, v66, v6
    v_mul_f32 v67, v67, v6
    v_mul_f32 v68, v68, v6
    v_mul_f32 v69, v69, v6
    v_mul_f32 v70, v70, v6
    v_mul_f32 v71, v71, v6
Lnomax_14:
    v_fma_f32 v16, v16, s10, -v3
    v_fma_f32 v17, v17, s10, -v3
    v_fma_f32 v18, v18, s10, -v3
    v_fma_f32 v19, v19, s10, -v3
    v_fma_f32 v20, v20, s10, -v3
    v_fma_f32 v21, v21, s10, -v3
    v_fma_f32 v22, v22, s10, -v3
    v_fma_f32 v23, v23, s10, -v3
    v_exp_f32 v16, v16
    v_exp_f32 v17, v17
    v_exp_f32 v18, v18
    v_exp_f32 v19, v19
    v_exp_f32 v20, v20
    v_exp_f32 v21, v21
    v_exp_f32 v22, v22
    v_exp_f32 v23, v23
    v_add_f32 v5, v16, v17
    v_add_f32 v6, v18, v19
    v_add_f32 v7, v20, v21
    v_add_f32 v4, v4, v22
    v_add_f32 v5, v5, v6
    v_add_f32 v7, v7, v23
    v_add_f32 v4, v4, v5
    v_add_f32 v4, v4, v7
    v_cvt_pk_bf16_f32 v16, v16, v17
    v_cvt_pk_bf16_f32 v17, v18, v19
    v_cvt_pk_bf16_f32 v18, v20, v21
    v_cvt_pk_bf16_f32 v19, v22, v23
    s_waitcnt vmcnt(48)
    v_perm_b32 v72, v204, v200, s12
    v_perm_b32 v73, v212, v208, s12
    v_perm_b32 v74, v220, v216, s12
    v_perm_b32 v75, v228, v224, s12
    v_perm_b32 v76, v204, v200, s13
    v_perm_b32 v77, v212, v208, s13
    v_perm_b32 v78, v220, v216, s13
    v_perm_b32 v79, v228, v224, s13
    v_mfma_f32_16x16x32_bf16 v[40:43], v[72:75], v[16:19], v[40:43]
    v_perm_b32 v80, v205, v201, s12
    v_perm_b32 v81, v213, v209, s12
    v_perm_b32 v82, v221, v217, s12
    v_perm_b32 v83, v229, v225, s12
    v_mfma_f32_16x16x32_bf16 v[44:47], v[76:79], v[16:19], v[44:47]
    v_perm_b32 v84, v205, v201, s13
    v_perm_b32 v85, v213, v209, s13
    v_perm_b32 v86, v221, v217, s13
    v_perm_b32 v87, v229, v225, s13
    v_mfma_f32_16x16x32_bf16 v[48:51], v[80:83], v[16:19], v[48:51]
    v_perm_b32 v88, v206, v202, s12
    v_perm_b32 v89, v214, v210, s12
    v_perm_b32 v90, v222, v218, s12
    v_perm_b32 v91, v230, v226, s12
    v_mfma_f32_16x16x32_bf16 v[52:55], v[84:87], v[16:19], v[52:55]
    v_perm_b32 v92, v206, v202, s13
    v_perm_b32 v93, v214, v210, s13
    v_perm_b32 v94, v222, v218, s13
    v_perm_b32 v95, v230, v226, s13
    v_mfma_f32_16x16x32_bf16 v[56:59], v[88:91], v[16:19], v[56:59]
    v_perm_b32 v96, v207, v203, s12
    v_perm_b32 v97, v215, v211, s12
    v_perm_b32 v98, v223, v219, s12
    v_perm_b32 v99, v231, v227, s12
    v_mfma_f32_16x16x32_bf16 v[60:63], v[92:95], v[16:19], v[60:63]
    v_perm_b32 v100, v207, v203, s13
    v_perm_b32 v101, v215, v211, s13
    v_perm_b32 v102, v223, v219, s13
    v_perm_b32 v103, v231, v227, s13
    v_mfma_f32_16x16x32_bf16 v[64:67], v[96:99], v[16:19], v[64:67]
    s_nop 0
    v_mfma_f32_16x16x32_bf16 v[68:71], v[100:103], v[16:19], v[68:71]
    s_cmp_eq_u32 s9, 0
    s_cbranch_scc0 Lti_12
    s_waitcnt vmcnt(0)
    s_branch Ltk_13
Lti_12:
    s_add_u32 m0, s87, 24576
    s_nop 0
    buffer_load_dwordx4 v8, s[44:47], s90 offen offset:0 nt lds
    buffer_load_dwordx4 v9, s[44:47], s90 offen offset:1024 nt lds
    buffer_load_dwordx4 v10, s[44:47], s90 offen offset:2048 nt lds
    buffer_load_dwordx4 v11, s[44:47], s90 offen offset:3072 nt lds
    s_add_u32 m0, s87, 28672
    s_nop 0
    buffer_load_dwordx4 v8, s[44:47], s91 offen offset:0 nt lds
    buffer_load_dwordx4 v9, s[44:47], s91 offen offset:1024 nt lds
    buffer_load_dwordx4 v10, s[44:47], s91 offen offset:2048 nt lds
    buffer_load_dwordx4 v11, s[44:47], s91 offen offset:3072 nt lds
    buffer_load_dwordx4 v[200:203], v1, s[48:51], s90 offen offset:0 nt
    buffer_load_dwordx4 v[204:207], v1, s[48:51], s90 offen offset:1024 nt
    buffer_load_dwordx4 v[208:211], v1, s[48:51], s90 offen offset:2048 nt
    buffer_load_dwordx4 v[212:215], v1, s[48:51], s90 offen offset:3072 nt
    buffer_load_dwordx4 v[216:219], v1, s[48:51], s91 offen offset:0 nt
    buffer_load_dwordx4 v[220:223], v1, s[48:51], s91 offen offset:1024 nt
    buffer_load_dwordx4 v[224:227], v1, s[48:51], s91 offen offset:2048 nt
    buffer_load_dwordx4 v[228:231], v1, s[48:51], s91 offen offset:3072 nt
Ltk_13:
    s_nop 3
    s_branch L_Sloop
L_Sdone:
    v_mov_b32 v5, v4
    s_nop 1
    v_permlane16_swap_b32 v4, v5
    v_add_f32 v4, v4, v5
    v_mov_b32 v5, v4
    s_nop 1
    v_permlane32_swap_b32 v4, v5
    v_add_f32 v4, v4, v5
    v_lshrrev_b32 v5, 4, v1
    v_and_b32 v6, 15, v5
    v_lshrrev_b32 v7, 4, v5
    v_lshlrev_b32 v16, 9, v6
    v_lshl_add_u32 v16, v7, 4, v16
    s_lshl_b32 s14, s3, 11
    v_add_u32 v16, s14, v16
    v_lshlrev_b32 v17, 5, v6
    s_lshl_b32 s14, s3, 3
    v_add_u32 v17, s14, v17
    v_mov_b32 v6, v3
    v_mov_b32 v7, v4
    s_mov_b32 exec_lo, 0x000f000f
    s_mov_b32 exec_hi, 0x000f000f
    ds_write_b128 v16, v[40:43] offset:8192
    ds_write_b128 v16, v[44:47] offset:8256
    ds_write_b128 v16, v[48:51] offset:8320
    ds_write_b128 v16, v[52:55] offset:8384
    ds_write_b128 v16, v[56:59] offset:8448
    ds_write_b128 v16, v[60:63] offset:8512
    ds_write_b128 v16, v[64:67] offset:8576
    ds_write_b128 v16, v[68:71] offset:8640
    s_mov_b32 exec_lo, 0xf
    s_mov_b32 exec_hi, 0
    ds_write_b64 v17, v[6:7] offset:2560
    s_mov_b64 exec, -1
    v_mov_b32 v5, 0
    v_mov_b32 v4, 1
    s_waitcnt lgkmcnt(0)
    s_mov_b32 exec_lo, 1
    s_mov_b32 exec_hi, 0
    ds_add_u32 v5, v4 offset:8
    s_mov_b64 exec, -1
    s_branch L_end
L_T:
    s_setprio 2
    v_mov_b32 v3, 1
    s_cmp_ge_u32 s2, 192
    s_cbranch_scc1 L_TW
    s_lshl_b32 s85, s4, 2
    s_add_u32 s85, s85, s3
    s_mul_i32 s98, s85, 2304
    s_add_u32 s98, s98, 4096
    s_mul_i32 s85, s85, 24
    s_add_u32 s85, s85, s5
    s_mul_i32 s85, s85, 640
    s_add_u32 s85, s85, 196608
    v_mov_b32 v8, -1
    v_mov_b32 v9, -1
    v_mov_b32 v10, -1
    v_mov_b32 v11, -1
    v_lshlrev_b32 v18, 2, v0
    s_lshl_b32 s12, s3, 8
    v_add_u32 v18, s12, v18
    v_lshrrev_b32 v17, 5, v0
    v_and_b32 v7, 31, v0
    v_lshlrev_b32 v7, 4, v7
    v_lshl_add_u32 v7, v17, 11, v7
    s_lshl_b32 s12, s3, 9
    v_add_u32 v7, s12, v7
    s_lshl_b32 s12, s3, 5
    v_mov_b32 v19, s12
    s_waitcnt lgkmcnt(0)
    s_load_dword s42, s[40:41], 0
    s_mov_b32 s60, s40
    s_mov_b32 s61, s41
    s_mov_b32 s62, 0x142000
    s_mov_b32 s63, 0x20000
    s_mov_b32 s64, s38
    s_mov_b32 s65, s39
    s_mov_b32 s66, 0x100
    s_mov_b32 s67, 0x20000
    s_sleep 40
    s_mov_b32 exec_lo, -1
    s_mov_b32 exec_hi, 0
    buffer_store_dwordx4 v[8:11], v1, s[60:63], s85 offen sc1
    s_mov_b32 exec_lo, 1
    s_mov_b32 exec_hi, 0
    buffer_store_dword v8, v1, s[60:63], s85 offen offset:512 sc1
    s_mov_b64 exec, -1
    s_waitcnt lgkmcnt(0)
    s_add_u32 s96, s42, 1
    s_mul_i32 s97, s96, 0x9E3779B1
    s_add_u32 s97, s97, 0x7F4A7C15
    v_mov_b32 v102, s96
    v_mov_b32 v103, s97
    s_sleep 60
    s_mov_b32 s58, 0
    s_mov_b32 s15, 262144
LsgQ_15_all:
    buffer_load_dwordx4 v[20:23], v1, s[60:63], s98 offen offset:0 sc1
    buffer_load_dwordx4 v[24:27], v1, s[60:63], s98 offen offset:1152 sc1
    s_sub_u32 s15, s15, 1
    s_cbranch_scc1 L_end
    s_waitcnt vmcnt(0)
    s_mov_b32 s58, 0
    v_cmp_ne_u64 vcc, v[22:23], v[102:103]
    s_cmp_lg_u64 vcc, 0
    s_cselect_b32 s14, 0x1, 0
    s_or_b32 s58, s58, s14
    v_cmp_ne_u64 vcc, v[26:27], v[102:103]
    s_cmp_lg_u64 vcc, 0
    s_cselect_b32 s14, 0x2, 0
    s_or_b32 s58, s58, s14
    s_cmp_eq_u32 s58, 0
    s_cbranch_scc1 LsgQ_15_done
LsgQ_15:
    s_sleep 24
    s_bitcmp1_b32 s58, 0
    s_cbranch_scc1 LsgQ_15_ld0
LsgQ_15_ldr0:
    s_bitcmp1_b32 s58, 1
    s_cbranch_scc1 LsgQ_15_ld1
LsgQ_15_ldr1:
    s_sub_u32 s15, s15, 1
    s_cbranch_scc1 L_end
    s_waitcnt vmcnt(0)
    s_bitcmp1_b32 s58, 0
    s_cbranch_scc1 LsgQ_15_ck0
LsgQ_15_ckr0:
    s_bitcmp1_b32 s58, 1
    s_cbranch_scc1 LsgQ_15_ck1
LsgQ_15_ckr1:
    s_cmp_lg_u32 s58, 0
    s_cbranch_scc1 LsgQ_15
    s_branch LsgQ_15_done
LsgQ_15_ld0:
    buffer_load_dwordx4 v[20:23], v1, s[60:63], s98 offen offset:0 sc1
    s_branch LsgQ_15_ldr0
LsgQ_15_ck0:
    v_cmp_ne_u64 vcc, v[22:23], v[102:103]
    s_nop 4
    s_cbranch_vccnz LsgQ_15_ckr0
    s_bitset0_b32 s58, 0
    s_branch LsgQ_15_ckr0
LsgQ_15_ld1:
    buffer_load_dwordx4 v[24:27], v1, s[60:63], s98 offen offset:1152 sc1
    s_branch LsgQ_15_ldr1
LsgQ_15_ck1:
    v_cmp_ne_u64 vcc, v[26:27], v[102:103]
    s_nop 4
    s_cbranch_vccnz LsgQ_15_ckr1
    s_bitset0_b32 s58, 1
    s_branch LsgQ_15_ckr1
LsgQ_15_done:
    v_pk_add_f32 v[20:21], v[20:21], v[24:25]
    v_cvt_pk_bf16_f32 v24, v20, v21
    ds_write_b32 v18, v24 offset:1536
    s_waitcnt lgkmcnt(0)
    s_mov_b32 exec_lo, 1
    s_mov_b32 exec_hi, 0
    ds_add_u32 v2, v3 offset:4
    s_mov_b64 exec, -1
    s_mov_b32 exec_lo, 1
    s_mov_b32 exec_hi, 0
    ds_add_rtn_u32 v80, v2, v3 offset:24
    s_waitcnt lgkmcnt(0)
    v_readfirstlane_b32 s14, v80
    s_cmp_lg_u32 s14, 3
    s_cbranch_scc1 Lnarr_16
    v_mov_b32 v80, 1
    buffer_atomic_add v80, v2, s[64:67], 0 offen sc0 sc1
    s_waitcnt vmcnt(0)
    v_readfirstlane_b32 s14, v80
    s_cmp_lg_u32 s14, 255
    s_cbranch_scc1 Lnarr_16
    buffer_store_dword v3, v2, s[64:67], 0 offen offset:128 sc1
Lnarr_16:
    s_mov_b64 exec, -1
    v_cmp_le_u32 s[80:81], 32, v0
    s_setprio 0
    s_mov_b32 s15, 4194304
Lw_17:
    ds_read_b32 v80, v2 offset:8
    s_sub_u32 s15, s15, 1
    s_cbranch_scc1 L_end
    s_waitcnt lgkmcnt(0)
    v_readfirstlane_b32 s14, v80
    s_cmp_ge_u32 s14, 4
    s_cbranch_scc1 Lwd_18
    s_sleep 1
    s_nop 1
    s_branch Lw_17
Lwd_18:
    s_setprio 3
    ds_read_b128 v[20:23], v19 offset:2560
    ds_read_b128 v[24:27], v19 offset:2576
    ds_read_b128 v[28:31], v7 offset:8192
    ds_read_b128 v[32:35], v7 offset:12288
    s_waitcnt lgkmcnt(2)
    v_max3_f32 v36, v20, v22, v24
    v_max_f32 v36, v36, v26
    v_sub_f32 v20, v20, v36
    v_sub_f32 v22, v22, v36
    v_sub_f32 v24, v24, v36
    v_sub_f32 v26, v26, v36
    v_exp_f32 v20, v20
    v_exp_f32 v22, v22
    v_exp_f32 v24, v24
    v_exp_f32 v26, v26
    v_mul_f32 v37, v20, v21
    v_fmac_f32 v37, v22, v23
    v_fmac_f32 v37, v24, v25
    v_fmac_f32 v37, v26, v27
    v_cndmask_b32 v38, v20, v22, s[80:81]
    v_cndmask_b32 v39, v24, v26, s[80:81]
    v_rcp_f32 v40, v37
    v_log_f32 v41, v37
    s_waitcnt lgkmcnt(0)
    v_mul_f32 v38, v38, v40
    v_mul_f32 v39, v39, v40
    v_add_f32 v41, v41, v36
    v_mul_f32 v28, v28, v38
    v_mul_f32 v29, v29, v38
    v_mul_f32 v30, v30, v38
    v_mul_f32 v31, v31, v38
    v_fmac_f32 v28, v32, v39
    v_fmac_f32 v29, v33, v39
    v_fmac_f32 v30, v34, v39
    v_fmac_f32 v31, v35, v39
    v_mov_b32 v32, v28
    v_mov_b32 v33, v29
    v_mov_b32 v34, v30
    v_mov_b32 v35, v31
    v_permlane32_swap_b32 v28, v32
    v_permlane32_swap_b32 v29, v33
    v_permlane32_swap_b32 v30, v34
    v_permlane32_swap_b32 v31, v35
    v_add_f32 v28, v28, v32
    v_add_f32 v29, v29, v33
    v_add_f32 v30, v30, v34
    v_add_f32 v31, v31, v35
    s_mov_b32 exec_lo, -1
    s_mov_b32 exec_hi, 0
    buffer_store_dwordx4 v[28:31], v1, s[60:63], s85 offen sc1
    s_mov_b32 exec_lo, 1
    s_mov_b32 exec_hi, 0
    buffer_store_dword v41, v2, s[60:63], s85 offen offset:512 sc1
    s_mov_b64 exec, -1
    s_branch L_end
L_TW:
    s_sub_u32 s5, s2, 192
    s_lshr_b32 s6, s5, 3
    s_and_b32 s6, s6, 3
    s_lshl_b32 s7, s4, 2
    s_add_u32 s6, s6, s7
    s_lshr_b32 s7, s5, 5
    s_cmp_lt_u32 s5, 56
    s_cselect_b32 s8, 1, 0
    s_and_b32 s10, s5, 15
    s_lshr_b32 s99, s5, 4
    s_lshl_b32 s99, s99, 2
    s_add_u32 s99, s99, s3
    v_lshrrev_b32 v17, 3, v0
    v_and_b32 v18, 7, v0
    v_lshrrev_b32 v5, 4, v0
    v_and_b32 v19, 15, v0
    v_lshlrev_b32 v4, 3, v17
    v_mul_u32_u24 v68, 24576, v17
    v_lshl_add_u32 v68, v18, 4, v68
    v_lshlrev_b32 v69, 4, v5
    v_lshl_add_u32 v69, v18, 6, v69
    v_and_b32 v6, 31, v0
    v_lshlrev_b32 v6, 2, v6
    v_lshlrev_b32 v7, 15, v5
    v_lshl_add_u32 v7, v19, 4, v7
    s_lshl_b32 s12, s99, 6
    s_mul_i32 s13, s99, 196608
    s_lshl_b32 s14, s10, 7
    s_add_u32 s13, s13, s14
    s_lshl_b32 s9, s7, 2
    s_add_u32 s9, s9, s3
    s_lshl_b32 s14, s9, 7
    s_lshl_b32 s15, s9, 19
    s_lshl_b32 s90, s6, 8
    s_add_u32 s15, s15, s90
    s_waitcnt lgkmcnt(0)
    s_load_dword s42, s[40:41], 0
    s_mov_b32 s48, s32
    s_mov_b32 s49, s33
    s_mov_b32 s50, 0x400
    s_mov_b32 s51, 0x20000
    s_mov_b32 s52, s34
    s_mov_b32 s53, s35
    s_mov_b32 s54, 0x300000
    s_mov_b32 s55, 0x20000
    buffer_load_dwordx2 v[12:13], v4, s[48:51], s12 offen
    buffer_load_dwordx4 v[20:23], v68, s[52:55], s13 offen nt
    s_add_u32 s13, s13, 6144
    buffer_load_dwordx4 v[24:27], v68, s[52:55], s13 offen nt
    s_add_u32 s13, s13, 6144
    buffer_load_dwordx4 v[28:31], v68, s[52:55], s13 offen nt
    s_add_u32 s13, s13, 6144
    buffer_load_dwordx4 v[32:35], v68, s[52:55], s13 offen nt
    s_mov_b32 s44, s16
    s_mov_b32 s45, s17
    s_mov_b32 s46, 0x400
    s_mov_b32 s47, 0x20000
    buffer_load_dwordx4 v[8:11], v1, s[44:47], 0 offen
    buffer_load_dword v16, v6, s[44:47], s14 offen
    s_mov_b32 s56, s22
    s_mov_b32 s57, s23
    s_mov_b32 s58, 0x400000
    s_mov_b32 s59, 0x20000
    s_add_u32 s12, s15, 0
    buffer_load_dwordx4 v[168:171], v7, s[56:59], s12 offen nt
    s_add_u32 s12, s15, 8192
    buffer_load_dwordx4 v[172:175], v7, s[56:59], s12 offen nt
    s_add_u32 s12, s15, 16384
    buffer_load_dwordx4 v[176:179], v7, s[56:59], s12 offen nt
    s_add_u32 s12, s15, 24576
    buffer_load_dwordx4 v[180:183], v7, s[56:59], s12 offen nt
    s_add_u32 s12, s15, 131072
    buffer_load_dwordx4 v[184:187], v7, s[56:59], s12 offen nt
    s_add_u32 s12, s15, 139264
    buffer_load_dwordx4 v[188:191], v7, s[56:59], s12 offen nt
    s_add_u32 s12, s15, 147456
    buffer_load_dwordx4 v[192:195], v7, s[56:59], s12 offen nt
    s_add_u32 s12, s15, 155648
    buffer_load_dwordx4 v[196:199], v7, s[56:59], s12 offen nt
    s_add_u32 s12, s15, 262144
    buffer_load_dwordx4 v[200:203], v7, s[56:59], s12 offen nt
    s_add_u32 s12, s15, 270336
    buffer_load_dwordx4 v[204:207], v7, s[56:59], s12 offen nt
    s_add_u32 s12, s15, 278528
    buffer_load_dwordx4 v[208:211], v7, s[56:59], s12 offen nt
    s_add_u32 s12, s15, 286720
    buffer_load_dwordx4 v[212:215], v7, s[56:59], s12 offen nt
    s_add_u32 s12, s15, 393216
    buffer_load_dwordx4 v[216:219], v7, s[56:59], s12 offen nt
    s_add_u32 s12, s15, 401408
    buffer_load_dwordx4 v[220:223], v7, s[56:59], s12 offen nt
    s_add_u32 s12, s15, 409600
    buffer_load_dwordx4 v[224:227], v7, s[56:59], s12 offen nt
    s_add_u32 s12, s15, 417792
    buffer_load_dwordx4 v[228:231], v7, s[56:59], s12 offen nt
    s_mov_b32 s60, s40
    s_mov_b32 s61, s41
    s_mov_b32 s62, 0x142000
    s_mov_b32 s63, 0x20000
    s_mov_b32 s64, s38
    s_mov_b32 s65, s39
    s_mov_b32 s66, 0x100
    s_mov_b32 s67, 0x20000
    s_mov_b32 s68, s24
    s_mov_b32 s69, s25
    s_mov_b32 s70, 0x400000
    s_mov_b32 s71, 0x20000
    s_mov_b32 s72, s28
    s_mov_b32 s73, s29
    s_mov_b32 s74, 0x1c0000
    s_mov_b32 s75, 0x20000
    s_mov_b32 s76, s30
    s_mov_b32 s77, s31
    s_mov_b32 s78, 0x1c0000
    s_mov_b32 s79, 0x20000
    s_mov_b32 s90, s36
    s_mov_b32 s91, s37
    s_mul_i32 s89, s10, 8320
    s_lshl_b32 s12, s99, 9
    s_add_u32 s89, s89, s12
    s_add_u32 s89, s89, 917504
    s_mul_i32 s86, s9, 8320
    s_add_u32 s86, s86, 917504
    s_lshl_b32 s84, s6, 1
    s_add_u32 s84, s84, s7
    s_mul_i32 s84, s84, 1152
    s_lshl_b32 s12, s3, 8
    s_add_u32 s84, s84, s12
    s_add_u32 s84, s84, 4096
    s_lshl_b32 s87, s6, 11
    s_lshl_b32 s13, s7, 10
    s_add_u32 s87, s87, s13
    s_add_u32 s87, s87, s12
    s_add_u32 s87, s87, 720896
    s_lshl_b32 s88, s5, 11
    s_lshl_b32 s12, s3, 9
    s_add_u32 s88, s88, s12
    s_add_u32 s88, s88, 786432
    s_waitcnt lgkmcnt(0)
    s_add_u32 s96, s42, 1
    s_mul_i32 s97, s96, 0x9E3779B1
    s_add_u32 s97, s97, 0x7F4A7C15
    v_mov_b32 v102, s96
    v_mov_b32 v103, s97
    s_waitcnt vmcnt(22)
    v_lshlrev_b32 v82, 16, v12
    v_and_b32 v83, s83, v12
    v_lshlrev_b32 v84, 16, v13
    v_and_b32 v85, s83, v13
    v_mul_f32 v86, 0xbfb8aa3b, v82
    v_mul_f32 v87, 0xbfb8aa3b, v83
    v_mul_f32 v88, 0xbfb8aa3b, v84
    v_mul_f32 v89, 0xbfb8aa3b, v85
    v_exp_f32 v86, v86
    v_exp_f32 v87, v87
    v_exp_f32 v88, v88
    v_exp_f32 v89, v89
    v_add_f32 v86, 1.0, v86
    v_add_f32 v87, 1.0, v87
    v_add_f32 v88, 1.0, v88
    v_add_f32 v89, 1.0, v89
    v_rcp_f32 v86, v86
    v_rcp_f32 v87, v87
    v_rcp_f32 v88, v88
    v_rcp_f32 v89, v89
    v_mul_f32 v82, v82, v86
    v_mul_f32 v83, v83, v87
    v_mul_f32 v84, v84, v88
    v_mul_f32 v85, v85, v89
    v_cvt_pk_bf16_f32 v80, v82, v83
    v_cvt_pk_bf16_f32 v81, v84, v85
    v_lshlrev_b32 v82, 16, v80
    v_and_b32 v83, s83, v80
    v_and_b32 v90, 0xffff, v80
    v_lshrrev_b32 v91, 16, v80
    v_lshlrev_b32 v84, 16, v81
    v_and_b32 v85, s83, v81
    v_and_b32 v92, 0xffff, v81
    v_lshrrev_b32 v93, 16, v81
    s_waitcnt vmcnt(21)
    v_dot2_f32_bf16 v232, v20, v90, 0
    v_dot2_f32_bf16 v233, v20, v82, 0
    v_dot2_f32_bf16 v234, v21, v90, 0
    v_dot2_f32_bf16 v235, v21, v82, 0
    v_dot2_f32_bf16 v236, v22, v90, 0
    v_dot2_f32_bf16 v237, v22, v82, 0
    v_dot2_f32_bf16 v238, v23, v90, 0
    v_dot2_f32_bf16 v239, v23, v82, 0
    s_waitcnt vmcnt(20)
    v_dot2c_f32_bf16 v232, v24, v91
    v_dot2c_f32_bf16 v233, v24, v83
    v_dot2c_f32_bf16 v234, v25, v91
    v_dot2c_f32_bf16 v235, v25, v83
    v_dot2c_f32_bf16 v236, v26, v91
    v_dot2c_f32_bf16 v237, v26, v83
    v_dot2c_f32_bf16 v238, v27, v91
    v_dot2c_f32_bf16 v239, v27, v83
    s_waitcnt vmcnt(19)
    v_dot2c_f32_bf16 v232, v28, v92
    v_dot2c_f32_bf16 v233, v28, v84
    v_dot2c_f32_bf16 v234, v29, v92
    v_dot2c_f32_bf16 v235, v29, v84
    v_dot2c_f32_bf16 v236, v30, v92
    v_dot2c_f32_bf16 v237, v30, v84
    v_dot2c_f32_bf16 v238, v31, v92
    v_dot2c_f32_bf16 v239, v31, v84
    s_waitcnt vmcnt(18)
    v_dot2c_f32_bf16 v232, v32, v93
    v_dot2c_f32_bf16 v233, v32, v85
    v_dot2c_f32_bf16 v234, v33, v93
    v_dot2c_f32_bf16 v235, v33, v85
    v_dot2c_f32_bf16 v236, v34, v93
    v_dot2c_f32_bf16 v237, v34, v85
    v_dot2c_f32_bf16 v238, v35, v93
    v_dot2c_f32_bf16 v239, v35, v85
    v_permlane32_swap_b32 v232, v236
    v_permlane32_swap_b32 v233, v237
    v_permlane32_swap_b32 v234, v238
    v_permlane32_swap_b32 v235, v239
    v_add_f32 v232, v232, v236
    v_add_f32 v233, v233, v237
    v_add_f32 v234, v234, v238
    v_add_f32 v235, v235, v239
    s_nop 0
    v_permlane16_swap_b32 v232, v234
    v_permlane16_swap_b32 v233, v235
    v_add_f32 v232, v232, v234
    v_add_f32 v233, v233, v235
    s_nop 0
    v_add_f32 v232, v232, v232 row_ror:8
    v_add_f32 v233, v233, v233 row_ror:8
    v_mov_b32 v234, s96
    v_mov_b32 v235, s97
    s_mov_b32 exec_lo, 0x00ff00ff
    s_mov_b32 exec_hi, 0x00ff00ff
    buffer_store_dwordx4 v[232:235], v69, s[60:63], s89 offen sc1
    s_mov_b64 exec, -1
    s_waitcnt vmcnt(17)
    v_lshlrev_b32 v70, 16, v8
    v_and_b32 v71, s83, v8
    v_lshlrev_b32 v72, 16, v9
    v_and_b32 v73, s83, v9
    v_lshlrev_b32 v74, 16, v10
    v_and_b32 v75, s83, v10
    v_lshlrev_b32 v76, 16, v11
    v_and_b32 v77, s83, v11
    v_readfirstlane_b32 s14, v70
    s_nop 1
    v_subrev_f32 v70, s14, v70
    v_subrev_f32 v71, s14, v71
    v_subrev_f32 v72, s14, v72
    v_subrev_f32 v73, s14, v73
    v_subrev_f32 v74, s14, v74
    v_subrev_f32 v75, s14, v75
    v_subrev_f32 v76, s14, v76
    v_subrev_f32 v77, s14, v77
    v_add_f32 v78, v70, v71
    v_mul_f32 v79, v70, v70
    v_fmac_f32 v79, v71, v71
    v_add_f32 v78, v78, v72
    v_fmac_f32 v79, v72, v72
    v_add_f32 v78, v78, v73
    v_fmac_f32 v79, v73, v73
    v_add_f32 v78, v78, v74
    v_fmac_f32 v79, v74, v74
    v_add_f32 v78, v78, v75
    v_fmac_f32 v79, v75, v75
    v_add_f32 v78, v78, v76
    v_fmac_f32 v79, v76, v76
    v_add_f32 v78, v78, v77
    v_fmac_f32 v79, v77, v77
    s_nop 0
    v_add_f32 v78, v78, v78 row_ror:1
    v_add_f32 v79, v79, v79 row_ror:1
    s_nop 0
    v_add_f32 v78, v78, v78 row_ror:2
    v_add_f32 v79, v79, v79 row_ror:2
    s_nop 0
    v_add_f32 v78, v78, v78 row_ror:4
    v_add_f32 v79, v79, v79 row_ror:4
    s_nop 0
    v_add_f32 v78, v78, v78 row_ror:8
    v_add_f32 v79, v79, v79 row_ror:8
    v_mov_b32 v80, v78
    v_mov_b32 v81, v79
    s_nop 0
    v_permlane16_swap_b32 v78, v80
    v_permlane16_swap_b32 v79, v81
    v_add_f32 v78, v78, v80
    v_add_f32 v79, v79, v81
    v_mov_b32 v80, v78
    v_mov_b32 v81, v79
    s_nop 0
    v_permlane32_swap_b32 v78, v80
    v_permlane32_swap_b32 v79, v81
    v_add_f32 v78, v78, v80
    v_add_f32 v79, v79, v81
    v_mul_f32 v78, 0x3b000000, v78
    v_mul_f32 v79, 0x3b000000, v79
    v_fma_f32 v79, -v78, v78, v79
    v_add_f32 v78, s14, v78
    v_max_f32 v79, 0, v79
    v_cvt_pk_bf16_f32 v80, v78, v79
    v_lshlrev_b32 v78, 16, v80
    v_and_b32 v79, s83, v80
    v_add_f32 v79, 0x3727c5ac, v79
    v_cvt_pk_bf16_f32 v79, v79, v79
    v_lshlrev_b32 v79, 16, v79
    v_sqrt_f32 v79, v79
    s_nop 0
    v_cvt_pk_bf16_f32 v79, v79, v79
    v_lshlrev_b32 v79, 16, v79
    v_rcp_f32 v79, v79
    v_lshlrev_b32 v12, 16, v16
    v_and_b32 v13, s83, v16
    v_sub_f32 v12, v12, v78
    v_sub_f32 v13, v13, v78
    v_cvt_pk_bf16_f32 v80, v12, v13
    v_lshlrev_b32 v12, 16, v80
    v_and_b32 v13, s83, v80
    v_mul_f32 v12, v12, v79
    v_mul_f32 v13, v13, v79
    v_cvt_pk_bf16_f32 v80, v12, v13
    v_lshlrev_b32 v12, 16, v80
    v_and_b32 v13, s83, v80
    s_lshl_b32 s12, s3, 7
    v_add_u32 v6, s12, v6
    v_lshl_add_u32 v4, v5, 3, s12
    v_lshlrev_b32 v7, 5, v19
    v_lshl_add_u32 v7, v5, 3, v7
    s_lshl_b32 s13, s3, 9
    v_add_u32 v7, s13, v7
    v_lshl_add_u32 v16, v0, 3, s12
    s_sleep 8
    s_add_u32 s32, s86, 0
    s_add_u32 s33, s32, 4096
    s_add_u32 s34, s86, 66560
    s_add_u32 s35, s34, 4096
    s_mov_b32 s58, 0
    s_mov_b32 s15, 262144
LsgA_19_all:
    buffer_load_dwordx4 v[104:107], v1, s[60:63], s32 offen offset:0 sc1
    buffer_load_dwordx4 v[108:111], v1, s[60:63], s32 offen offset:1024 sc1
    buffer_load_dwordx4 v[112:115], v1, s[60:63], s32 offen offset:2048 sc1
    buffer_load_dwordx4 v[116:119], v1, s[60:63], s32 offen offset:3072 sc1
    buffer_load_dwordx4 v[120:123], v1, s[60:63], s33 offen offset:0 sc1
    buffer_load_dwordx4 v[124:127], v1, s[60:63], s33 offen offset:1024 sc1
    buffer_load_dwordx4 v[128:131], v1, s[60:63], s33 offen offset:2048 sc1
    buffer_load_dwordx4 v[132:135], v1, s[60:63], s33 offen offset:3072 sc1
    buffer_load_dwordx4 v[136:139], v1, s[60:63], s34 offen offset:0 sc1
    buffer_load_dwordx4 v[140:143], v1, s[60:63], s34 offen offset:1024 sc1
    buffer_load_dwordx4 v[144:147], v1, s[60:63], s34 offen offset:2048 sc1
    buffer_load_dwordx4 v[148:151], v1, s[60:63], s34 offen offset:3072 sc1
    buffer_load_dwordx4 v[152:155], v1, s[60:63], s35 offen offset:0 sc1
    buffer_load_dwordx4 v[156:159], v1, s[60:63], s35 offen offset:1024 sc1
    buffer_load_dwordx4 v[160:163], v1, s[60:63], s35 offen offset:2048 sc1
    buffer_load_dwordx4 v[164:167], v1, s[60:63], s35 offen offset:3072 sc1
    s_sub_u32 s15, s15, 1
    s_cbranch_scc1 L_end
    s_waitcnt vmcnt(0)
    s_mov_b32 s58, 0
    v_cmp_ne_u64 vcc, v[106:107], v[102:103]
    v_cmp_ne_u64 s[80:81], v[110:111], v[102:103]
    s_or_b64 vcc, vcc, s[80:81]
    s_cmp_lg_u64 vcc, 0
    s_cselect_b32 s14, 0x1, 0
    s_or_b32 s58, s58, s14
    v_cmp_ne_u64 vcc, v[114:115], v[102:103]
    v_cmp_ne_u64 s[80:81], v[118:119], v[102:103]
    s_or_b64 vcc, vcc, s[80:81]
    s_cmp_lg_u64 vcc, 0
    s_cselect_b32 s14, 0x2, 0
    s_or_b32 s58, s58, s14
    v_cmp_ne_u64 vcc, v[122:123], v[102:103]
    v_cmp_ne_u64 s[80:81], v[126:127], v[102:103]
    s_or_b64 vcc, vcc, s[80:81]
    s_cmp_lg_u64 vcc, 0
    s_cselect_b32 s14, 0x4, 0
    s_or_b32 s58, s58, s14
    v_cmp_ne_u64 vcc, v[130:131], v[102:103]
    v_cmp_ne_u64 s[80:81], v[134:135], v[102:103]
    s_or_b64 vcc, vcc, s[80:81]
    s_cmp_lg_u64 vcc, 0
    s_cselect_b32 s14, 0x8, 0
    s_or_b32 s58, s58, s14
    v_cmp_ne_u64 vcc, v[138:139], v[102:103]
    v_cmp_ne_u64 s[80:81], v[142:143], v[102:103]
    s_or_b64 vcc, vcc, s[80:81]
    s_cmp_lg_u64 vcc, 0
    s_cselect_b32 s14, 0x10, 0
    s_or_b32 s58, s58, s14
    v_cmp_ne_u64 vcc, v[146:147], v[102:103]
    v_cmp_ne_u64 s[80:81], v[150:151], v[102:103]
    s_or_b64 vcc, vcc, s[80:81]
    s_cmp_lg_u64 vcc, 0
    s_cselect_b32 s14, 0x20, 0
    s_or_b32 s58, s58, s14
    v_cmp_ne_u64 vcc, v[154:155], v[102:103]
    v_cmp_ne_u64 s[80:81], v[158:159], v[102:103]
    s_or_b64 vcc, vcc, s[80:81]
    s_cmp_lg_u64 vcc, 0
    s_cselect_b32 s14, 0x40, 0
    s_or_b32 s58, s58, s14
    v_cmp_ne_u64 vcc, v[162:163], v[102:103]
    v_cmp_ne_u64 s[80:81], v[166:167], v[102:103]
    s_or_b64 vcc, vcc, s[80:81]
    s_cmp_lg_u64 vcc, 0
    s_cselect_b32 s14, 0x80, 0
    s_or_b32 s58, s58, s14
    s_cmp_eq_u32 s58, 0
    s_cbranch_scc1 LsgA_19_done
LsgA_19:
    s_sleep 4
    s_bitcmp1_b32 s58, 0
    s_cbranch_scc1 LsgA_19_ld0
LsgA_19_ldr0:
    s_bitcmp1_b32 s58, 1
    s_cbranch_scc1 LsgA_19_ld1
LsgA_19_ldr1:
    s_bitcmp1_b32 s58, 2
    s_cbranch_scc1 LsgA_19_ld2
LsgA_19_ldr2:
    s_bitcmp1_b32 s58, 3
    s_cbranch_scc1 LsgA_19_ld3
LsgA_19_ldr3:
    s_bitcmp1_b32 s58, 4
    s_cbranch_scc1 LsgA_19_ld4
LsgA_19_ldr4:
    s_bitcmp1_b32 s58, 5
    s_cbranch_scc1 LsgA_19_ld5
LsgA_19_ldr5:
    s_bitcmp1_b32 s58, 6
    s_cbranch_scc1 LsgA_19_ld6
LsgA_19_ldr6:
    s_bitcmp1_b32 s58, 7
    s_cbranch_scc1 LsgA_19_ld7
LsgA_19_ldr7:
    s_sub_u32 s15, s15, 1
    s_cbranch_scc1 L_end
    s_waitcnt vmcnt(0)
    s_bitcmp1_b32 s58, 0
    s_cbranch_scc1 LsgA_19_ck0
LsgA_19_ckr0:
    s_bitcmp1_b32 s58, 1
    s_cbranch_scc1 LsgA_19_ck1
LsgA_19_ckr1:
    s_bitcmp1_b32 s58, 2
    s_cbranch_scc1 LsgA_19_ck2
LsgA_19_ckr2:
    s_bitcmp1_b32 s58, 3
    s_cbranch_scc1 LsgA_19_ck3
LsgA_19_ckr3:
    s_bitcmp1_b32 s58, 4
    s_cbranch_scc1 LsgA_19_ck4
LsgA_19_ckr4:
    s_bitcmp1_b32 s58, 5
    s_cbranch_scc1 LsgA_19_ck5
LsgA_19_ckr5:
    s_bitcmp1_b32 s58, 6
    s_cbranch_scc1 LsgA_19_ck6
LsgA_19_ckr6:
    s_bitcmp1_b32 s58, 7
    s_cbranch_scc1 LsgA_19_ck7
LsgA_19_ckr7:
    s_cmp_lg_u32 s58, 0
    s_cbranch_scc1 LsgA_19
    s_branch LsgA_19_done
LsgA_19_ld0:
    buffer_load_dwordx4 v[104:107], v1, s[60:63], s32 offen offset:0 sc1
    buffer_load_dwordx4 v[108:111], v1, s[60:63], s32 offen offset:1024 sc1
    s_branch LsgA_19_ldr0
LsgA_19_ck0:
    v_cmp_ne_u64 vcc, v[106:107], v[102:103]
    v_cmp_ne_u64 s[80:81], v[110:111], v[102:103]
    s_or_b64 vcc, vcc, s[80:81]
    s_nop 3
    s_cbranch_vccnz LsgA_19_ckr0
    s_bitset0_b32 s58, 0
    s_branch LsgA_19_ckr0
LsgA_19_ld1:
    buffer_load_dwordx4 v[112:115], v1, s[60:63], s32 offen offset:2048 sc1
    buffer_load_dwordx4 v[116:119], v1, s[60:63], s32 offen offset:3072 sc1
    s_branch LsgA_19_ldr1
LsgA_19_ck1:
    v_cmp_ne_u64 vcc, v[114:115], v[102:103]
    v_cmp_ne_u64 s[80:81], v[118:119], v[102:103]
    s_or_b64 vcc, vcc, s[80:81]
    s_nop 3
    s_cbranch_vccnz LsgA_19_ckr1
    s_bitset0_b32 s58, 1
    s_branch LsgA_19_ckr1
LsgA_19_ld2:
    buffer_load_dwordx4 v[120:123], v1, s[60:63], s33 offen offset:0 sc1
    buffer_load_dwordx4 v[124:127], v1, s[60:63], s33 offen offset:1024 sc1
    s_branch LsgA_19_ldr2
LsgA_19_ck2:
    v_cmp_ne_u64 vcc, v[122:123], v[102:103]
    v_cmp_ne_u64 s[80:81], v[126:127], v[102:103]
    s_or_b64 vcc, vcc, s[80:81]
    s_nop 3
    s_cbranch_vccnz LsgA_19_ckr2
    s_bitset0_b32 s58, 2
    s_branch LsgA_19_ckr2
LsgA_19_ld3:
    buffer_load_dwordx4 v[128:131], v1, s[60:63], s33 offen offset:2048 sc1
    buffer_load_dwordx4 v[132:135], v1, s[60:63], s33 offen offset:3072 sc1
    s_branch LsgA_19_ldr3
LsgA_19_ck3:
    v_cmp_ne_u64 vcc, v[130:131], v[102:103]
    v_cmp_ne_u64 s[80:81], v[134:135], v[102:103]
    s_or_b64 vcc, vcc, s[80:81]
    s_nop 3
    s_cbranch_vccnz LsgA_19_ckr3
    s_bitset0_b32 s58, 3
    s_branch LsgA_19_ckr3
LsgA_19_ld4:
    buffer_load_dwordx4 v[136:139], v1, s[60:63], s34 offen offset:0 sc1
    buffer_load_dwordx4 v[140:143], v1, s[60:63], s34 offen offset:1024 sc1
    s_branch LsgA_19_ldr4
LsgA_19_ck4:
    v_cmp_ne_u64 vcc, v[138:139], v[102:103]
    v_cmp_ne_u64 s[80:81], v[142:143], v[102:103]
    s_or_b64 vcc, vcc, s[80:81]
    s_nop 3
    s_cbranch_vccnz LsgA_19_ckr4
    s_bitset0_b32 s58, 4
    s_branch LsgA_19_ckr4
LsgA_19_ld5:
    buffer_load_dwordx4 v[144:147], v1, s[60:63], s34 offen offset:2048 sc1
    buffer_load_dwordx4 v[148:151], v1, s[60:63], s34 offen offset:3072 sc1
    s_branch LsgA_19_ldr5
LsgA_19_ck5:
    v_cmp_ne_u64 vcc, v[146:147], v[102:103]
    v_cmp_ne_u64 s[80:81], v[150:151], v[102:103]
    s_or_b64 vcc, vcc, s[80:81]
    s_nop 3
    s_cbranch_vccnz LsgA_19_ckr5
    s_bitset0_b32 s58, 5
    s_branch LsgA_19_ckr5
LsgA_19_ld6:
    buffer_load_dwordx4 v[152:155], v1, s[60:63], s35 offen offset:0 sc1
    buffer_load_dwordx4 v[156:159], v1, s[60:63], s35 offen offset:1024 sc1
    s_branch LsgA_19_ldr6
LsgA_19_ck6:
    v_cmp_ne_u64 vcc, v[154:155], v[102:103]
    v_cmp_ne_u64 s[80:81], v[158:159], v[102:103]
    s_or_b64 vcc, vcc, s[80:81]
    s_nop 3
    s_cbranch_vccnz LsgA_19_ckr6
    s_bitset0_b32 s58, 6
    s_branch LsgA_19_ckr6
LsgA_19_ld7:
    buffer_load_dwordx4 v[160:163], v1, s[60:63], s35 offen offset:2048 sc1
    buffer_load_dwordx4 v[164:167], v1, s[60:63], s35 offen offset:3072 sc1
    s_branch LsgA_19_ldr7
LsgA_19_ck7:
    v_cmp_ne_u64 vcc, v[162:163], v[102:103]
    v_cmp_ne_u64 s[80:81], v[166:167], v[102:103]
    s_or_b64 vcc, vcc, s[80:81]
    s_nop 3
    s_cbranch_vccnz LsgA_19_ckr7
    s_bitset0_b32 s58, 7
    s_branch LsgA_19_ckr7
LsgA_19_done:
    v_pk_add_f32 v[104:105], v[104:105], v[108:109]
    v_pk_add_f32 v[104:105], v[104:105], v[112:113]
    v_pk_add_f32 v[104:105], v[104:105], v[116:117]
    v_pk_add_f32 v[104:105], v[104:105], v[120:121]
    v_pk_add_f32 v[104:105], v[104:105], v[124:125]
    v_pk_add_f32 v[104:105], v[104:105], v[128:129]
    v_pk_add_f32 v[104:105], v[104:105], v[132:133]
    v_pk_add_f32 v[136:137], v[136:137], v[140:141]
    v_pk_add_f32 v[136:137], v[136:137], v[144:145]
    v_pk_add_f32 v[136:137], v[136:137], v[148:149]
    v_pk_add_f32 v[136:137], v[136:137], v[152:153]
    v_pk_add_f32 v[136:137], v[136:137], v[156:157]
    v_pk_add_f32 v[136:137], v[136:137], v[160:161]
    v_pk_add_f32 v[136:137], v[136:137], v[164:165]
    v_mov_b32 v70, v104
    v_mov_b32 v71, v105
    v_mov_b32 v72, v136
    v_mov_b32 v73, v137
    v_mov_b32 v112, v70
    v_mov_b32 v113, v71
    v_mov_b32 v114, v72
    v_mov_b32 v115, v73
    v_permlane32_swap_b32 v70, v112
    v_permlane32_swap_b32 v71, v113
    v_permlane32_swap_b32 v72, v114
    v_permlane32_swap_b32 v73, v115
    v_add_f32 v70, v70, v112
    v_add_f32 v71, v71, v113
    v_add_f32 v72, v72, v114
    v_add_f32 v73, v73, v115
    v_cvt_pk_bf16_f32 v108, v70, v71
    v_cvt_pk_bf16_f32 v109, v72, v73
    v_lshlrev_b32 v70, 16, v108
    v_and_b32 v71, s83, v108
    v_lshlrev_b32 v72, 16, v109
    v_and_b32 v73, s83, v109
    v_add_f32 v72, 1.0, v72
    v_add_f32 v73, 1.0, v73
    v_cvt_pk_bf16_f32 v108, v72, v73
    v_lshlrev_b32 v72, 16, v108
    v_and_b32 v73, s83, v108
    v_mul_f32 v72, v12, v72
    v_mul_f32 v73, v13, v73
    v_cvt_pk_bf16_f32 v108, v72, v73
    v_lshlrev_b32 v72, 16, v108
    v_and_b32 v73, s83, v108
    v_add_f32 v70, v72, v70
    v_add_f32 v71, v73, v71
    v_cvt_pk_bf16_f32 v108, v70, v71
    s_mov_b32 exec_lo, -1
    s_mov_b32 exec_hi, 0
    ds_write_b32 v6, v108 offset:256
    s_mov_b64 exec, -1
    ds_read_b64 v[112:113], v4 offset:256
    ds_read_b64 v[114:115], v4 offset:288
    ds_read_b64 v[116:117], v4 offset:320
    ds_read_b64 v[118:119], v4 offset:352
    s_waitcnt lgkmcnt(3)
    v_lshlrev_b32 v120, 16, v112
    v_and_b32 v121, s83, v112
    v_and_b32 v124, 0xffff, v112
    v_lshrrev_b32 v125, 16, v112
    v_lshlrev_b32 v122, 16, v113
    v_and_b32 v123, s83, v113
    v_and_b32 v126, 0xffff, v113
    v_lshrrev_b32 v127, 16, v113
    v_dot2_f32_bf16 v232, v168, v124, 0
    v_dot2_f32_bf16 v233, v168, v120, 0
    v_dot2_f32_bf16 v234, v169, v124, 0
    v_dot2_f32_bf16 v235, v169, v120, 0
    v_dot2_f32_bf16 v236, v170, v124, 0
    v_dot2_f32_bf16 v237, v170, v120, 0
    v_dot2_f32_bf16 v238, v171, v124, 0
    v_dot2_f32_bf16 v239, v171, v120, 0
    v_dot2c_f32_bf16 v232, v172, v125
    v_dot2c_f32_bf16 v233, v172, v121
    v_dot2c_f32_bf16 v234, v173, v125
    v_dot2c_f32_bf16 v235, v173, v121
    v_dot2c_f32_bf16 v236, v174, v125
    v_dot2c_f32_bf16 v237, v174, v121
    v_dot2c_f32_bf16 v238, v175, v125
    v_dot2c_f32_bf16 v239, v175, v121
    v_dot2c_f32_bf16 v232, v176, v126
    v_dot2c_f32_bf16 v233, v176, v122
    v_dot2c_f32_bf16 v234, v177, v126
    v_dot2c_f32_bf16 v235, v177, v122
    v_dot2c_f32_bf16 v236, v178, v126
    v_dot2c_f32_bf16 v237, v178, v122
    v_dot2c_f32_bf16 v238, v179, v126
    v_dot2c_f32_bf16 v239, v179, v122
    v_dot2c_f32_bf16 v232, v180, v127
    v_dot2c_f32_bf16 v233, v180, v123
    v_dot2c_f32_bf16 v234, v181, v127
    v_dot2c_f32_bf16 v235, v181, v123
    v_dot2c_f32_bf16 v236, v182, v127
    v_dot2c_f32_bf16 v237, v182, v123
    v_dot2c_f32_bf16 v238, v183, v127
    v_dot2c_f32_bf16 v239, v183, v123
    s_waitcnt lgkmcnt(2)
    v_lshlrev_b32 v128, 16, v114
    v_and_b32 v129, s83, v114
    v_and_b32 v132, 0xffff, v114
    v_lshrrev_b32 v133, 16, v114
    v_lshlrev_b32 v130, 16, v115
    v_and_b32 v131, s83, v115
    v_and_b32 v134, 0xffff, v115
    v_lshrrev_b32 v135, 16, v115
    v_dot2c_f32_bf16 v232, v184, v132
    v_dot2c_f32_bf16 v233, v184, v128
    v_dot2c_f32_bf16 v234, v185, v132
    v_dot2c_f32_bf16 v235, v185, v128
    v_dot2c_f32_bf16 v236, v186, v132
    v_dot2c_f32_bf16 v237, v186, v128
    v_dot2c_f32_bf16 v238, v187, v132
    v_dot2c_f32_bf16 v239, v187, v128
    v_dot2c_f32_bf16 v232, v188, v133
    v_dot2c_f32_bf16 v233, v188, v129
    v_dot2c_f32_bf16 v234, v189, v133
    v_dot2c_f32_bf16 v235, v189, v129
    v_dot2c_f32_bf16 v236, v190, v133
    v_dot2c_f32_bf16 v237, v190, v129
    v_dot2c_f32_bf16 v238, v191, v133
    v_dot2c_f32_bf16 v239, v191, v129
    v_dot2c_f32_bf16 v232, v192, v134
    v_dot2c_f32_bf16 v233, v192, v130
    v_dot2c_f32_bf16 v234, v193, v134
    v_dot2c_f32_bf16 v235, v193, v130
    v_dot2c_f32_bf16 v236, v194, v134
    v_dot2c_f32_bf16 v237, v194, v130
    v_dot2c_f32_bf16 v238, v195, v134
    v_dot2c_f32_bf16 v239, v195, v130
    v_dot2c_f32_bf16 v232, v196, v135
    v_dot2c_f32_bf16 v233, v196, v131
    v_dot2c_f32_bf16 v234, v197, v135
    v_dot2c_f32_bf16 v235, v197, v131
    v_dot2c_f32_bf16 v236, v198, v135
    v_dot2c_f32_bf16 v237, v198, v131
    v_dot2c_f32_bf16 v238, v199, v135
    v_dot2c_f32_bf16 v239, v199, v131
    s_waitcnt lgkmcnt(1)
    v_lshlrev_b32 v136, 16, v116
    v_and_b32 v137, s83, v116
    v_and_b32 v140, 0xffff, v116
    v_lshrrev_b32 v141, 16, v116
    v_lshlrev_b32 v138, 16, v117
    v_and_b32 v139, s83, v117
    v_and_b32 v142, 0xffff, v117
    v_lshrrev_b32 v143, 16, v117
    v_dot2c_f32_bf16 v232, v200, v140
    v_dot2c_f32_bf16 v233, v200, v136
    v_dot2c_f32_bf16 v234, v201, v140
    v_dot2c_f32_bf16 v235, v201, v136
    v_dot2c_f32_bf16 v236, v202, v140
    v_dot2c_f32_bf16 v237, v202, v136
    v_dot2c_f32_bf16 v238, v203, v140
    v_dot2c_f32_bf16 v239, v203, v136
    v_dot2c_f32_bf16 v232, v204, v141
    v_dot2c_f32_bf16 v233, v204, v137
    v_dot2c_f32_bf16 v234, v205, v141
    v_dot2c_f32_bf16 v235, v205, v137
    v_dot2c_f32_bf16 v236, v206, v141
    v_dot2c_f32_bf16 v237, v206, v137
    v_dot2c_f32_bf16 v238, v207, v141
    v_dot2c_f32_bf16 v239, v207, v137
    v_dot2c_f32_bf16 v232, v208, v142
    v_dot2c_f32_bf16 v233, v208, v138
    v_dot2c_f32_bf16 v234, v209, v142
    v_dot2c_f32_bf16 v235, v209, v138
    v_dot2c_f32_bf16 v236, v210, v142
    v_dot2c_f32_bf16 v237, v210, v138
    v_dot2c_f32_bf16 v238, v211, v142
    v_dot2c_f32_bf16 v239, v211, v138
    v_dot2c_f32_bf16 v232, v212, v143
    v_dot2c_f32_bf16 v233, v212, v139
    v_dot2c_f32_bf16 v234, v213, v143
    v_dot2c_f32_bf16 v235, v213, v139
    v_dot2c_f32_bf16 v236, v214, v143
    v_dot2c_f32_bf16 v237, v214, v139
    v_dot2c_f32_bf16 v238, v215, v143
    v_dot2c_f32_bf16 v239, v215, v139
    s_waitcnt lgkmcnt(0)
    v_lshlrev_b32 v144, 16, v118
    v_and_b32 v145, s83, v118
    v_and_b32 v148, 0xffff, v118
    v_lshrrev_b32 v149, 16, v118
    v_lshlrev_b32 v146, 16, v119
    v_and_b32 v147, s83, v119
    v_and_b32 v150, 0xffff, v119
    v_lshrrev_b32 v151, 16, v119
    v_dot2c_f32_bf16 v232, v216, v148
    v_dot2c_f32_bf16 v233, v216, v144
    v_dot2c_f32_bf16 v234, v217, v148
    v_dot2c_f32_bf16 v235, v217, v144
    v_dot2c_f32_bf16 v236, v218, v148
    v_dot2c_f32_bf16 v237, v218, v144
    v_dot2c_f32_bf16 v238, v219, v148
    v_dot2c_f32_bf16 v239, v219, v144
    v_dot2c_f32_bf16 v232, v220, v149
    v_dot2c_f32_bf16 v233, v220, v145
    v_dot2c_f32_bf16 v234, v221, v149
    v_dot2c_f32_bf16 v235, v221, v145
    v_dot2c_f32_bf16 v236, v222, v149
    v_dot2c_f32_bf16 v237, v222, v145
    v_dot2c_f32_bf16 v238, v223, v149
    v_dot2c_f32_bf16 v239, v223, v145
    v_dot2c_f32_bf16 v232, v224, v150
    v_dot2c_f32_bf16 v233, v224, v146
    v_dot2c_f32_bf16 v234, v225, v150
    v_dot2c_f32_bf16 v235, v225, v146
    v_dot2c_f32_bf16 v236, v226, v150
    v_dot2c_f32_bf16 v237, v226, v146
    v_dot2c_f32_bf16 v238, v227, v150
    v_dot2c_f32_bf16 v239, v227, v146
    v_dot2c_f32_bf16 v232, v228, v151
    v_dot2c_f32_bf16 v233, v228, v147
    v_dot2c_f32_bf16 v234, v229, v151
    v_dot2c_f32_bf16 v235, v229, v147
    v_dot2c_f32_bf16 v236, v230, v151
    v_dot2c_f32_bf16 v237, v230, v147
    v_dot2c_f32_bf16 v238, v231, v151
    v_dot2c_f32_bf16 v239, v231, v147
    v_permlane32_swap_b32 v232, v236
    v_permlane32_swap_b32 v233, v237
    v_permlane32_swap_b32 v234, v238
    v_permlane32_swap_b32 v235, v239
    v_add_f32 v232, v232, v236
    v_add_f32 v233, v233, v237
    v_add_f32 v234, v234, v238
    v_add_f32 v235, v235, v239
    s_nop 0
    v_permlane16_swap_b32 v232, v234
    v_permlane16_swap_b32 v233, v235
    v_add_f32 v232, v232, v234
    v_add_f32 v233, v233, v235
    ds_write_b64 v7, v[232:233] offset:8192
    s_waitcnt lgkmcnt(0)
    s_mov_b32 exec_lo, 1
    s_mov_b32 exec_hi, 0
    ds_add_u32 v2, v3 offset:40
    s_mov_b64 exec, -1
    v_mov_b32 v234, s96
    v_mov_b32 v235, s97
    s_mov_b32 s15, 4194304
Lw_20:
    ds_read_b32 v80, v2 offset:40
    s_sub_u32 s15, s15, 1
    s_cbranch_scc1 L_end
    s_waitcnt lgkmcnt(0)
    v_readfirstlane_b32 s14, v80
    s_cmp_ge_u32 s14, 4
    s_nop 3
    s_cbranch_scc0 Lw_20
    s_mov_b32 exec_lo, 0xffff
    s_mov_b32 exec_hi, 0
    ds_read_b64 v[104:105], v16 offset:8192
    ds_read_b64 v[106:107], v16 offset:8704
    ds_read_b64 v[108:109], v16 offset:9216
    ds_read_b64 v[110:111], v16 offset:9728
    s_waitcnt lgkmcnt(0)
    v_pk_add_f32 v[104:105], v[104:105], v[106:107]
    v_pk_add_f32 v[108:109], v[108:109], v[110:111]
    v_pk_add_f32 v[232:233], v[104:105], v[108:109]
    buffer_store_dwordx4 v[232:235], v1, s[60:63], s84 offen sc1
    s_mov_b64 exec, -1
    v_lshlrev_b32 v4, 3, v17
    s_lshl_b32 s12, s5, 2
    s_add_u32 s12, s12, s3
    s_and_b32 s10, s12, 31
    s_add_u32 s10, s10, 16
    s_lshr_b32 s99, s12, 5
    s_lshl_b32 s12, s99, 6
    s_mul_i32 s13, s99, 196608
    s_lshl_b32 s14, s10, 7
    s_add_u32 s13, s13, s14
    buffer_load_dwordx2 v[100:101], v4, s[48:51], s12 offen
    buffer_load_dwordx2 v[244:245], v4, s[48:51], s12 offen offset:512
    s_add_u32 s12, s13, 0
    buffer_load_dwordx4 v[20:23], v68, s[52:55], s12 offen nt
    s_add_u32 s12, s13, 6144
    buffer_load_dwordx4 v[24:27], v68, s[52:55], s12 offen nt
    s_add_u32 s12, s13, 12288
    buffer_load_dwordx4 v[28:31], v68, s[52:55], s12 offen nt
    s_add_u32 s12, s13, 18432
    buffer_load_dwordx4 v[32:35], v68, s[52:55], s12 offen nt
    s_add_u32 s12, s13, 1572864
    buffer_load_dwordx4 v[36:39], v68, s[52:55], s12 offen nt
    s_add_u32 s12, s13, 1579008
    buffer_load_dwordx4 v[40:43], v68, s[52:55], s12 offen nt
    s_add_u32 s12, s13, 1585152
    buffer_load_dwordx4 v[44:47], v68, s[52:55], s12 offen nt
    s_add_u32 s12, s13, 1591296
    buffer_load_dwordx4 v[48:51], v68, s[52:55], s12 offen nt
    s_mul_i32 s89, s10, 8320
    s_lshl_b32 s12, s99, 9
    s_add_u32 s89, s89, s12
    s_add_u32 s89, s89, 917504
    s_add_u32 s99, s89, 4096
    v_lshlrev_b32 v18, 4, v18
    v_lshl_add_u32 v4, v17, 13, v18
    v_lshl_add_u32 v6, v17, 10, v18
    s_lshl_b32 s12, s6, 17
    s_lshl_b32 s13, s7, 9
    s_add_u32 s12, s12, s13
    s_lshl_b32 s13, s3, 7
    s_add_u32 s12, s12, s13
    s_add_u32 s13, s12, 0
    buffer_load_dwordx4 v[104:107], v4, s[68:71], s13 offen nt
    s_add_u32 s13, s12, 65536
    buffer_load_dwordx4 v[108:111], v4, s[68:71], s13 offen nt
    s_add_u32 s13, s12, 1024
    buffer_load_dwordx4 v[112:115], v4, s[68:71], s13 offen nt
    s_add_u32 s13, s12, 66560
    buffer_load_dwordx4 v[116:119], v4, s[68:71], s13 offen nt
    s_add_u32 s13, s12, 2048
    buffer_load_dwordx4 v[120:123], v4, s[68:71], s13 offen nt
    s_add_u32 s13, s12, 67584
    buffer_load_dwordx4 v[124:127], v4, s[68:71], s13 offen nt
    s_add_u32 s13, s12, 3072
    buffer_load_dwordx4 v[128:131], v4, s[68:71], s13 offen nt
    s_add_u32 s13, s12, 68608
    buffer_load_dwordx4 v[132:135], v4, s[68:71], s13 offen nt
    s_add_u32 s13, s12, 4096
    buffer_load_dwordx4 v[136:139], v4, s[68:71], s13 offen nt
    s_add_u32 s13, s12, 69632
    buffer_load_dwordx4 v[140:143], v4, s[68:71], s13 offen nt
    s_add_u32 s13, s12, 5120
    buffer_load_dwordx4 v[144:147], v4, s[68:71], s13 offen nt
    s_add_u32 s13, s12, 70656
    buffer_load_dwordx4 v[148:151], v4, s[68:71], s13 offen nt
    s_add_u32 s13, s12, 6144
    buffer_load_dwordx4 v[152:155], v4, s[68:71], s13 offen nt
    s_add_u32 s13, s12, 71680
    buffer_load_dwordx4 v[156:159], v4, s[68:71], s13 offen nt
    s_add_u32 s13, s12, 7168
    buffer_load_dwordx4 v[160:163], v4, s[68:71], s13 offen nt
    s_add_u32 s13, s12, 72704
    buffer_load_dwordx4 v[164:167], v4, s[68:71], s13 offen nt
    s_cmp_eq_u32 s8, 0
    s_cbranch_scc1 L_xnotM
    v_lshrrev_b32 v7, 2, v0
    v_mul_u32_u24 v7, 3584, v7
    v_and_b32 v16, 3, v0
    v_lshl_add_u32 v7, v16, 4, v7
    s_mul_i32 s12, s3, 458752
    s_lshl_b32 s13, s5, 6
    s_add_u32 s12, s12, s13
    buffer_load_dwordx4 v[168:171], v7, s[72:75], s12 offen nt
    s_add_u32 s12, s12, 57344
    buffer_load_dwordx4 v[172:175], v7, s[72:75], s12 offen nt
    s_add_u32 s12, s12, 57344
    buffer_load_dwordx4 v[176:179], v7, s[72:75], s12 offen nt
    s_add_u32 s12, s12, 57344
    buffer_load_dwordx4 v[180:183], v7, s[72:75], s12 offen nt
    s_add_u32 s12, s12, 57344
    buffer_load_dwordx4 v[184:187], v7, s[72:75], s12 offen nt
    s_add_u32 s12, s12, 57344
    buffer_load_dwordx4 v[188:191], v7, s[72:75], s12 offen nt
    s_add_u32 s12, s12, 57344
    buffer_load_dwordx4 v[192:195], v7, s[72:75], s12 offen nt
    s_add_u32 s12, s12, 57344
    buffer_load_dwordx4 v[196:199], v7, s[72:75], s12 offen nt
    s_lshl_b32 s12, s5, 15
    s_lshl_b32 s13, s3, 8
    s_add_u32 s12, s12, s13
    s_add_u32 s13, s12, 0
    buffer_load_dwordx4 v[200:203], v6, s[76:79], s13 offen offset:0 nt
    s_add_u32 s13, s12, 8192
    buffer_load_dwordx4 v[204:207], v6, s[76:79], s13 offen offset:0 nt
    s_add_u32 s13, s12, 16384
    buffer_load_dwordx4 v[208:211], v6, s[76:79], s13 offen offset:0 nt
    s_add_u32 s13, s12, 24576
    buffer_load_dwordx4 v[212:215], v6, s[76:79], s13 offen offset:0 nt
    s_add_u32 s13, s12, 0
    buffer_load_dwordx4 v[216:219], v6, s[76:79], s13 offen offset:128 nt
    s_add_u32 s13, s12, 8192
    buffer_load_dwordx4 v[220:223], v6, s[76:79], s13 offen offset:128 nt
    s_add_u32 s13, s12, 16384
    buffer_load_dwordx4 v[224:227], v6, s[76:79], s13 offen offset:128 nt
    s_add_u32 s13, s12, 24576
    buffer_load_dwordx4 v[228:231], v6, s[76:79], s13 offen offset:128 nt
    v_and_b32 v7, 31, v0
    v_lshlrev_b32 v7, 3, v7
    s_lshl_b32 s12, s3, 8
    buffer_load_dwordx2 v[98:99], v7, s[44:47], s12 offen
L_xnotM:
    v_mov_b32 v8, -1
    v_mov_b32 v9, -1
    v_mov_b32 v10, -1
    v_mov_b32 v11, -1
    s_mov_b32 exec_lo, 0xffff
    s_mov_b32 exec_hi, 0
    buffer_store_dwordx4 v[8:11], v1, s[60:63], s87 offen sc1
    s_cmp_eq_u32 s8, 0
    s_cbranch_scc1 L_nz
    s_mov_b32 exec_lo, -1
    s_mov_b32 exec_hi, 0
    buffer_store_dwordx4 v[8:11], v1, s[60:63], s88 offen sc1
L_nz:
    s_mov_b64 exec, -1
    s_waitcnt vmcnt(0)
    v_lshlrev_b32 v82, 16, v100
    v_and_b32 v83, s83, v100
    v_lshlrev_b32 v84, 16, v101
    v_and_b32 v85, s83, v101
    v_mul_f32 v86, 0xbfb8aa3b, v82
    v_mul_f32 v87, 0xbfb8aa3b, v83
    v_mul_f32 v88, 0xbfb8aa3b, v84
    v_mul_f32 v89, 0xbfb8aa3b, v85
    v_exp_f32 v86, v86
    v_exp_f32 v87, v87
    v_exp_f32 v88, v88
    v_exp_f32 v89, v89
    v_add_f32 v86, 1.0, v86
    v_add_f32 v87, 1.0, v87
    v_add_f32 v88, 1.0, v88
    v_add_f32 v89, 1.0, v89
    v_rcp_f32 v86, v86
    v_rcp_f32 v87, v87
    v_rcp_f32 v88, v88
    v_rcp_f32 v89, v89
    v_mul_f32 v82, v82, v86
    v_mul_f32 v83, v83, v87
    v_mul_f32 v84, v84, v88
    v_mul_f32 v85, v85, v89
    v_cvt_pk_bf16_f32 v80, v82, v83
    v_cvt_pk_bf16_f32 v81, v84, v85
    v_lshlrev_b32 v82, 16, v80
    v_and_b32 v83, s83, v80
    v_and_b32 v90, 0xffff, v80
    v_lshrrev_b32 v91, 16, v80
    v_lshlrev_b32 v84, 16, v81
    v_and_b32 v85, s83, v81
    v_and_b32 v92, 0xffff, v81
    v_lshrrev_b32 v93, 16, v81
    v_dot2_f32_bf16 v232, v20, v90, 0
    v_dot2_f32_bf16 v233, v20, v82, 0
    v_dot2_f32_bf16 v234, v21, v90, 0
    v_dot2_f32_bf16 v235, v21, v82, 0
    v_dot2_f32_bf16 v236, v22, v90, 0
    v_dot2_f32_bf16 v237, v22, v82, 0
    v_dot2_f32_bf16 v238, v23, v90, 0
    v_dot2_f32_bf16 v239, v23, v82, 0
    v_dot2c_f32_bf16 v232, v24, v91
    v_dot2c_f32_bf16 v233, v24, v83
    v_dot2c_f32_bf16 v234, v25, v91
    v_dot2c_f32_bf16 v235, v25, v83
    v_dot2c_f32_bf16 v236, v26, v91
    v_dot2c_f32_bf16 v237, v26, v83
    v_dot2c_f32_bf16 v238, v27, v91
    v_dot2c_f32_bf16 v239, v27, v83
    v_dot2c_f32_bf16 v232, v28, v92
    v_dot2c_f32_bf16 v233, v28, v84
    v_dot2c_f32_bf16 v234, v29, v92
    v_dot2c_f32_bf16 v235, v29, v84
    v_dot2c_f32_bf16 v236, v30, v92
    v_dot2c_f32_bf16 v237, v30, v84
    v_dot2c_f32_bf16 v238, v31, v92
    v_dot2c_f32_bf16 v239, v31, v84
    v_dot2c_f32_bf16 v232, v32, v93
    v_dot2c_f32_bf16 v233, v32, v85
    v_dot2c_f32_bf16 v234, v33, v93
    v_dot2c_f32_bf16 v235, v33, v85
    v_dot2c_f32_bf16 v236, v34, v93
    v_dot2c_f32_bf16 v237, v34, v85
    v_dot2c_f32_bf16 v238, v35, v93
    v_dot2c_f32_bf16 v239, v35, v85
    v_permlane32_swap_b32 v232, v236
    v_permlane32_swap_b32 v233, v237
    v_permlane32_swap_b32 v234, v238
    v_permlane32_swap_b32 v235, v239
    v_add_f32 v232, v232, v236
    v_add_f32 v233, v233, v237
    v_add_f32 v234, v234, v238
    v_add_f32 v235, v235, v239
    s_nop 0
    v_permlane16_swap_b32 v232, v234
    v_permlane16_swap_b32 v233, v235
    v_add_f32 v232, v232, v234
    v_add_f32 v233, v233, v235
    s_nop 0
    v_add_f32 v232, v232, v232 row_ror:8
    v_add_f32 v233, v233, v233 row_ror:8
    v_mov_b32 v234, s96
    v_mov_b32 v235, s97
    s_mov_b32 exec_lo, 0x00ff00ff
    s_mov_b32 exec_hi, 0x00ff00ff
    buffer_store_dwordx4 v[232:235], v69, s[60:63], s89 offen sc1
    s_mov_b64 exec, -1
    v_lshlrev_b32 v82, 16, v244
    v_and_b32 v83, s83, v244
    v_lshlrev_b32 v84, 16, v245
    v_and_b32 v85, s83, v245
    v_mul_f32 v86, 0xbfb8aa3b, v82
    v_mul_f32 v87, 0xbfb8aa3b, v83
    v_mul_f32 v88, 0xbfb8aa3b, v84
    v_mul_f32 v89, 0xbfb8aa3b, v85
    v_exp_f32 v86, v86
    v_exp_f32 v87, v87
    v_exp_f32 v88, v88
    v_exp_f32 v89, v89
    v_add_f32 v86, 1.0, v86
    v_add_f32 v87, 1.0, v87
    v_add_f32 v88, 1.0, v88
    v_add_f32 v89, 1.0, v89
    v_rcp_f32 v86, v86
    v_rcp_f32 v87, v87
    v_rcp_f32 v88, v88
    v_rcp_f32 v89, v89
    v_mul_f32 v82, v82, v86
    v_mul_f32 v83, v83, v87
    v_mul_f32 v84, v84, v88
    v_mul_f32 v85, v85, v89
    v_cvt_pk_bf16_f32 v80, v82, v83
    v_cvt_pk_bf16_f32 v81, v84, v85
    v_lshlrev_b32 v82, 16, v80
    v_and_b32 v83, s83, v80
    v_and_b32 v90, 0xffff, v80
    v_lshrrev_b32 v91, 16, v80
    v_lshlrev_b32 v84, 16, v81
    v_and_b32 v85, s83, v81
    v_and_b32 v92, 0xffff, v81
    v_lshrrev_b32 v93, 16, v81
    v_dot2_f32_bf16 v232, v36, v90, 0
    v_dot2_f32_bf16 v233, v36, v82, 0
    v_dot2_f32_bf16 v234, v37, v90, 0
    v_dot2_f32_bf16 v235, v37, v82, 0
    v_dot2_f32_bf16 v236, v38, v90, 0
    v_dot2_f32_bf16 v237, v38, v82, 0
    v_dot2_f32_bf16 v238, v39, v90, 0
    v_dot2_f32_bf16 v239, v39, v82, 0
    v_dot2c_f32_bf16 v232, v40, v91
    v_dot2c_f32_bf16 v233, v40, v83
    v_dot2c_f32_bf16 v234, v41, v91
    v_dot2c_f32_bf16 v235, v41, v83
    v_dot2c_f32_bf16 v236, v42, v91
    v_dot2c_f32_bf16 v237, v42, v83
    v_dot2c_f32_bf16 v238, v43, v91
    v_dot2c_f32_bf16 v239, v43, v83
    v_dot2c_f32_bf16 v232, v44, v92
    v_dot2c_f32_bf16 v233, v44, v84
    v_dot2c_f32_bf16 v234, v45, v92
    v_dot2c_f32_bf16 v235, v45, v84
    v_dot2c_f32_bf16 v236, v46, v92
    v_dot2c_f32_bf16 v237, v46, v84
    v_dot2c_f32_bf16 v238, v47, v92
    v_dot2c_f32_bf16 v239, v47, v84
    v_dot2c_f32_bf16 v232, v48, v93
    v_dot2c_f32_bf16 v233, v48, v85
    v_dot2c_f32_bf16 v234, v49, v93
    v_dot2c_f32_bf16 v235, v49, v85
    v_dot2c_f32_bf16 v236, v50, v93
    v_dot2c_f32_bf16 v237, v50, v85
    v_dot2c_f32_bf16 v238, v51, v93
    v_dot2c_f32_bf16 v239, v51, v85
    v_permlane32_swap_b32 v232, v236
    v_permlane32_swap_b32 v233, v237
    v_permlane32_swap_b32 v234, v238
    v_permlane32_swap_b32 v235, v239
    v_add_f32 v232, v232, v236
    v_add_f32 v233, v233, v237
    v_add_f32 v234, v234, v238
    v_add_f32 v235, v235, v239
    s_nop 0
    v_permlane16_swap_b32 v232, v234
    v_permlane16_swap_b32 v233, v235
    v_add_f32 v232, v232, v234
    v_add_f32 v233, v233, v235
    s_nop 0
    v_add_f32 v232, v232, v232 row_ror:8
    v_add_f32 v233, v233, v233 row_ror:8
    v_mov_b32 v234, s96
    v_mov_b32 v235, s97
    s_mov_b32 exec_lo, 0x00ff00ff
    s_mov_b32 exec_hi, 0x00ff00ff
    buffer_store_dwordx4 v[232:235], v69, s[60:63], s99 offen sc1
    s_mov_b64 exec, -1
    s_lshl_b32 s12, s3, 12
    v_add_u32 v19, s12, v1
    v_lshrrev_b32 v17, 4, v0
    v_and_b32 v18, 15, v0
    v_lshl_add_u32 v18, v18, 1, s12
    v_lshl_add_u32 v4, v17, 10, v18
    v_lshl_add_u32 v5, v17, 9, v18
    v_lshlrev_b32 v17, 4, v17
    s_waitcnt vmcnt(0)
    s_mov_b32 exec_lo, 1
    s_mov_b32 exec_hi, 0
    ds_add_rtn_u32 v80, v2, v3 offset:24
    s_waitcnt lgkmcnt(0)
    v_readfirstlane_b32 s14, v80
    s_cmp_lg_u32 s14, 3
    s_cbranch_scc1 Lnarr_22
    v_mov_b32 v80, 1
    buffer_atomic_add v80, v2, s[64:67], 0 offen sc0 sc1
    s_waitcnt vmcnt(0)
    v_readfirstlane_b32 s14, v80
    s_cmp_lg_u32 s14, 255
    s_cbranch_scc1 Lnarr_22
    buffer_store_dword v3, v2, s[64:67], 0 offen offset:128 sc1
Lnarr_22:
    s_mov_b64 exec, -1
    ds_write_b128 v19, v[104:107] offset:16384
    ds_write_b128 v19, v[108:111] offset:17408
    ds_write_b128 v19, v[112:115] offset:18432
    ds_write_b128 v19, v[116:119] offset:19456
    ds_read_u16 v20, v4 offset:16384
    ds_read_u16 v21, v4 offset:16512
    ds_read_u16 v22, v4 offset:16640
    ds_read_u16 v23, v4 offset:16768
    ds_read_u16 v24, v4 offset:16896
    ds_read_u16 v25, v4 offset:17024
    ds_read_u16 v26, v4 offset:17152
    ds_read_u16 v27, v4 offset:17280
    ds_read_u16 v28, v4 offset:16416
    ds_read_u16 v29, v4 offset:16544
    ds_read_u16 v30, v4 offset:16672
    ds_read_u16 v31, v4 offset:16800
    ds_read_u16 v32, v4 offset:16928
    ds_read_u16 v33, v4 offset:17056
    ds_read_u16 v34, v4 offset:17184
    ds_read_u16 v35, v4 offset:17312
    ds_read_u16 v36, v4 offset:16448
    ds_read_u16 v37, v4 offset:16576
    ds_read_u16 v38, v4 offset:16704
    ds_read_u16 v39, v4 offset:16832
    ds_read_u16 v40, v4 offset:16960
    ds_read_u16 v41, v4 offset:17088
    ds_read_u16 v42, v4 offset:17216
    ds_read_u16 v43, v4 offset:17344
    ds_read_u16 v44, v4 offset:16480
    ds_read_u16 v45, v4 offset:16608
    ds_read_u16 v46, v4 offset:16736
    ds_read_u16 v47, v4 offset:16864
    ds_read_u16 v48, v4 offset:16992
    ds_read_u16 v49, v4 offset:17120
    ds_read_u16 v50, v4 offset:17248
    ds_read_u16 v51, v4 offset:17376
    s_waitcnt lgkmcnt(0)
    v_lshl_or_b32 v104, v21, 16, v20
    v_lshl_or_b32 v105, v23, 16, v22
    v_lshl_or_b32 v106, v25, 16, v24
    v_lshl_or_b32 v107, v27, 16, v26
    v_lshl_or_b32 v108, v29, 16, v28
    v_lshl_or_b32 v109, v31, 16, v30
    v_lshl_or_b32 v110, v33, 16, v32
    v_lshl_or_b32 v111, v35, 16, v34
    v_lshl_or_b32 v112, v37, 16, v36
    v_lshl_or_b32 v113, v39, 16, v38
    v_lshl_or_b32 v114, v41, 16, v40
    v_lshl_or_b32 v115, v43, 16, v42
    v_lshl_or_b32 v116, v45, 16, v44
    v_lshl_or_b32 v117, v47, 16, v46
    v_lshl_or_b32 v118, v49, 16, v48
    v_lshl_or_b32 v119, v51, 16, v50
    ds_write_b128 v19, v[120:123] offset:16384
    ds_write_b128 v19, v[124:127] offset:17408
    ds_write_b128 v19, v[128:131] offset:18432
    ds_write_b128 v19, v[132:135] offset:19456
    ds_read_u16 v20, v4 offset:16384
    ds_read_u16 v21, v4 offset:16512
    ds_read_u16 v22, v4 offset:16640
    ds_read_u16 v23, v4 offset:16768
    ds_read_u16 v24, v4 offset:16896
    ds_read_u16 v25, v4 offset:17024
    ds_read_u16 v26, v4 offset:17152
    ds_read_u16 v27, v4 offset:17280
    ds_read_u16 v28, v4 offset:16416
    ds_read_u16 v29, v4 offset:16544
    ds_read_u16 v30, v4 offset:16672
    ds_read_u16 v31, v4 offset:16800
    ds_read_u16 v32, v4 offset:16928
    ds_read_u16 v33, v4 offset:17056
    ds_read_u16 v34, v4 offset:17184
    ds_read_u16 v35, v4 offset:17312
    ds_read_u16 v36, v4 offset:16448
    ds_read_u16 v37, v4 offset:16576
    ds_read_u16 v38, v4 offset:16704
    ds_read_u16 v39, v4 offset:16832
    ds_read_u16 v40, v4 offset:16960
    ds_read_u16 v41, v4 offset:17088
    ds_read_u16 v42, v4 offset:17216
    ds_read_u16 v43, v4 offset:17344
    ds_read_u16 v44, v4 offset:16480
    ds_read_u16 v45, v4 offset:16608
    ds_read_u16 v46, v4 offset:16736
    ds_read_u16 v47, v4 offset:16864
    ds_read_u16 v48, v4 offset:16992
    ds_read_u16 v49, v4 offset:17120
    ds_read_u16 v50, v4 offset:17248
    ds_read_u16 v51, v4 offset:17376
    s_waitcnt lgkmcnt(0)
    v_lshl_or_b32 v120, v21, 16, v20
    v_lshl_or_b32 v121, v23, 16, v22
    v_lshl_or_b32 v122, v25, 16, v24
    v_lshl_or_b32 v123, v27, 16, v26
    v_lshl_or_b32 v124, v29, 16, v28
    v_lshl_or_b32 v125, v31, 16, v30
    v_lshl_or_b32 v126, v33, 16, v32
    v_lshl_or_b32 v127, v35, 16, v34
    v_lshl_or_b32 v128, v37, 16, v36
    v_lshl_or_b32 v129, v39, 16, v38
    v_lshl_or_b32 v130, v41, 16, v40
    v_lshl_or_b32 v131, v43, 16, v42
    v_lshl_or_b32 v132, v45, 16, v44
    v_lshl_or_b32 v133, v47, 16, v46
    v_lshl_or_b32 v134, v49, 16, v48
    v_lshl_or_b32 v135, v51, 16, v50
    ds_write_b128 v19, v[136:139] offset:16384
    ds_write_b128 v19, v[140:143] offset:17408
    ds_write_b128 v19, v[144:147] offset:18432
    ds_write_b128 v19, v[148:151] offset:19456
    ds_read_u16 v20, v4 offset:16384
    ds_read_u16 v21, v4 offset:16512
    ds_read_u16 v22, v4 offset:16640
    ds_read_u16 v23, v4 offset:16768
    ds_read_u16 v24, v4 offset:16896
    ds_read_u16 v25, v4 offset:17024
    ds_read_u16 v26, v4 offset:17152
    ds_read_u16 v27, v4 offset:17280
    ds_read_u16 v28, v4 offset:16416
    ds_read_u16 v29, v4 offset:16544
    ds_read_u16 v30, v4 offset:16672
    ds_read_u16 v31, v4 offset:16800
    ds_read_u16 v32, v4 offset:16928
    ds_read_u16 v33, v4 offset:17056
    ds_read_u16 v34, v4 offset:17184
    ds_read_u16 v35, v4 offset:17312
    ds_read_u16 v36, v4 offset:16448
    ds_read_u16 v37, v4 offset:16576
    ds_read_u16 v38, v4 offset:16704
    ds_read_u16 v39, v4 offset:16832
    ds_read_u16 v40, v4 offset:16960
    ds_read_u16 v41, v4 offset:17088
    ds_read_u16 v42, v4 offset:17216
    ds_read_u16 v43, v4 offset:17344
    ds_read_u16 v44, v4 offset:16480
    ds_read_u16 v45, v4 offset:16608
    ds_read_u16 v46, v4 offset:16736
    ds_read_u16 v47, v4 offset:16864
    ds_read_u16 v48, v4 offset:16992
    ds_read_u16 v49, v4 offset:17120
    ds_read_u16 v50, v4 offset:17248
    ds_read_u16 v51, v4 offset:17376
    s_waitcnt lgkmcnt(0)
    v_lshl_or_b32 v136, v21, 16, v20
    v_lshl_or_b32 v137, v23, 16, v22
    v_lshl_or_b32 v138, v25, 16, v24
    v_lshl_or_b32 v139, v27, 16, v26
    v_lshl_or_b32 v140, v29, 16, v28
    v_lshl_or_b32 v141, v31, 16, v30
    v_lshl_or_b32 v142, v33, 16, v32
    v_lshl_or_b32 v143, v35, 16, v34
    v_lshl_or_b32 v144, v37, 16, v36
    v_lshl_or_b32 v145, v39, 16, v38
    v_lshl_or_b32 v146, v41, 16, v40
    v_lshl_or_b32 v147, v43, 16, v42
    v_lshl_or_b32 v148, v45, 16, v44
    v_lshl_or_b32 v149, v47, 16, v46
    v_lshl_or_b32 v150, v49, 16, v48
    v_lshl_or_b32 v151, v51, 16, v50
    ds_write_b128 v19, v[152:155] offset:16384
    ds_write_b128 v19, v[156:159] offset:17408
    ds_write_b128 v19, v[160:163] offset:18432
    ds_write_b128 v19, v[164:167] offset:19456
    ds_read_u16 v20, v4 offset:16384
    ds_read_u16 v21, v4 offset:16512
    ds_read_u16 v22, v4 offset:16640
    ds_read_u16 v23, v4 offset:16768
    ds_read_u16 v24, v4 offset:16896
    ds_read_u16 v25, v4 offset:17024
    ds_read_u16 v26, v4 offset:17152
    ds_read_u16 v27, v4 offset:17280
    ds_read_u16 v28, v4 offset:16416
    ds_read_u16 v29, v4 offset:16544
    ds_read_u16 v30, v4 offset:16672
    ds_read_u16 v31, v4 offset:16800
    ds_read_u16 v32, v4 offset:16928
    ds_read_u16 v33, v4 offset:17056
    ds_read_u16 v34, v4 offset:17184
    ds_read_u16 v35, v4 offset:17312
    ds_read_u16 v36, v4 offset:16448
    ds_read_u16 v37, v4 offset:16576
    ds_read_u16 v38, v4 offset:16704
    ds_read_u16 v39, v4 offset:16832
    ds_read_u16 v40, v4 offset:16960
    ds_read_u16 v41, v4 offset:17088
    ds_read_u16 v42, v4 offset:17216
    ds_read_u16 v43, v4 offset:17344
    ds_read_u16 v44, v4 offset:16480
    ds_read_u16 v45, v4 offset:16608
    ds_read_u16 v46, v4 offset:16736
    ds_read_u16 v47, v4 offset:16864
    ds_read_u16 v48, v4 offset:16992
    ds_read_u16 v49, v4 offset:17120
    ds_read_u16 v50, v4 offset:17248
    ds_read_u16 v51, v4 offset:17376
    s_waitcnt lgkmcnt(0)
    v_lshl_or_b32 v152, v21, 16, v20
    v_lshl_or_b32 v153, v23, 16, v22
    v_lshl_or_b32 v154, v25, 16, v24
    v_lshl_or_b32 v155, v27, 16, v26
    v_lshl_or_b32 v156, v29, 16, v28
    v_lshl_or_b32 v157, v31, 16, v30
    v_lshl_or_b32 v158, v33, 16, v32
    v_lshl_or_b32 v159, v35, 16, v34
    v_lshl_or_b32 v160, v37, 16, v36
    v_lshl_or_b32 v161, v39, 16, v38
    v_lshl_or_b32 v162, v41, 16, v40
    v_lshl_or_b32 v163, v43, 16, v42
    v_lshl_or_b32 v164, v45, 16, v44
    v_lshl_or_b32 v165, v47, 16, v46
    v_lshl_or_b32 v166, v49, 16, v48
    v_lshl_or_b32 v167, v51, 16, v50
    s_cmp_eq_u32 s8, 0
    s_cbranch_scc1 L_notM05
    ds_write_b128 v19, v[168:171] offset:16384
    ds_write_b128 v19, v[172:175] offset:17408
    ds_write_b128 v19, v[176:179] offset:18432
    ds_write_b128 v19, v[180:183] offset:19456
    ds_read_u16 v20, v5 offset:16384
    ds_read_u16 v21, v5 offset:16448
    ds_read_u16 v22, v5 offset:16512
    ds_read_u16 v23, v5 offset:16576
    ds_read_u16 v24, v5 offset:16640
    ds_read_u16 v25, v5 offset:16704
    ds_read_u16 v26, v5 offset:16768
    ds_read_u16 v27, v5 offset:16832
    ds_read_u16 v28, v5 offset:16416
    ds_read_u16 v29, v5 offset:16480
    ds_read_u16 v30, v5 offset:16544
    ds_read_u16 v31, v5 offset:16608
    ds_read_u16 v32, v5 offset:16672
    ds_read_u16 v33, v5 offset:16736
    ds_read_u16 v34, v5 offset:16800
    ds_read_u16 v35, v5 offset:16864
    ds_read_u16 v36, v5 offset:18432
    ds_read_u16 v37, v5 offset:18496
    ds_read_u16 v38, v5 offset:18560
    ds_read_u16 v39, v5 offset:18624
    ds_read_u16 v40, v5 offset:18688
    ds_read_u16 v41, v5 offset:18752
    ds_read_u16 v42, v5 offset:18816
    ds_read_u16 v43, v5 offset:18880
    ds_read_u16 v44, v5 offset:18464
    ds_read_u16 v45, v5 offset:18528
    ds_read_u16 v46, v5 offset:18592
    ds_read_u16 v47, v5 offset:18656
    ds_read_u16 v48, v5 offset:18720
    ds_read_u16 v49, v5 offset:18784
    ds_read_u16 v50, v5 offset:18848
    ds_read_u16 v51, v5 offset:18912
    s_waitcnt lgkmcnt(0)
    v_lshl_or_b32 v168, v21, 16, v20
    v_lshl_or_b32 v169, v23, 16, v22
    v_lshl_or_b32 v170, v25, 16, v24
    v_lshl_or_b32 v171, v27, 16, v26
    v_lshl_or_b32 v172, v29, 16, v28
    v_lshl_or_b32 v173, v31, 16, v30
    v_lshl_or_b32 v174, v33, 16, v32
    v_lshl_or_b32 v175, v35, 16, v34
    v_lshl_or_b32 v176, v37, 16, v36
    v_lshl_or_b32 v177, v39, 16, v38
    v_lshl_or_b32 v178, v41, 16, v40
    v_lshl_or_b32 v179, v43, 16, v42
    v_lshl_or_b32 v180, v45, 16, v44
    v_lshl_or_b32 v181, v47, 16, v46
    v_lshl_or_b32 v182, v49, 16, v48
    v_lshl_or_b32 v183, v51, 16, v50
    ds_write_b128 v19, v[184:187] offset:16384
    ds_write_b128 v19, v[188:191] offset:17408
    ds_write_b128 v19, v[192:195] offset:18432
    ds_write_b128 v19, v[196:199] offset:19456
    ds_read_u16 v20, v5 offset:16384
    ds_read_u16 v21, v5 offset:16448
    ds_read_u16 v22, v5 offset:16512
    ds_read_u16 v23, v5 offset:16576
    ds_read_u16 v24, v5 offset:16640
    ds_read_u16 v25, v5 offset:16704
    ds_read_u16 v26, v5 offset:16768
    ds_read_u16 v27, v5 offset:16832
    ds_read_u16 v28, v5 offset:16416
    ds_read_u16 v29, v5 offset:16480
    ds_read_u16 v30, v5 offset:16544
    ds_read_u16 v31, v5 offset:16608
    ds_read_u16 v32, v5 offset:16672
    ds_read_u16 v33, v5 offset:16736
    ds_read_u16 v34, v5 offset:16800
    ds_read_u16 v35, v5 offset:16864
    ds_read_u16 v36, v5 offset:18432
    ds_read_u16 v37, v5 offset:18496
    ds_read_u16 v38, v5 offset:18560
    ds_read_u16 v39, v5 offset:18624
    ds_read_u16 v40, v5 offset:18688
    ds_read_u16 v41, v5 offset:18752
    ds_read_u16 v42, v5 offset:18816
    ds_read_u16 v43, v5 offset:18880
    ds_read_u16 v44, v5 offset:18464
    ds_read_u16 v45, v5 offset:18528
    ds_read_u16 v46, v5 offset:18592
    ds_read_u16 v47, v5 offset:18656
    ds_read_u16 v48, v5 offset:18720
    ds_read_u16 v49, v5 offset:18784
    ds_read_u16 v50, v5 offset:18848
    ds_read_u16 v51, v5 offset:18912
    s_waitcnt lgkmcnt(0)
    v_lshl_or_b32 v184, v21, 16, v20
    v_lshl_or_b32 v185, v23, 16, v22
    v_lshl_or_b32 v186, v25, 16, v24
    v_lshl_or_b32 v187, v27, 16, v26
    v_lshl_or_b32 v188, v29, 16, v28
    v_lshl_or_b32 v189, v31, 16, v30
    v_lshl_or_b32 v190, v33, 16, v32
    v_lshl_or_b32 v191, v35, 16, v34
    v_lshl_or_b32 v192, v37, 16, v36
    v_lshl_or_b32 v193, v39, 16, v38
    v_lshl_or_b32 v194, v41, 16, v40
    v_lshl_or_b32 v195, v43, 16, v42
    v_lshl_or_b32 v196, v45, 16, v44
    v_lshl_or_b32 v197, v47, 16, v46
    v_lshl_or_b32 v198, v49, 16, v48
    v_lshl_or_b32 v199, v51, 16, v50
    ds_write_b128 v19, v[200:203] offset:16384
    ds_write_b128 v19, v[204:207] offset:17408
    ds_write_b128 v19, v[208:211] offset:18432
    ds_write_b128 v19, v[212:215] offset:19456
    ds_read_u16 v20, v4 offset:16384
    ds_read_u16 v21, v4 offset:16512
    ds_read_u16 v22, v4 offset:16640
    ds_read_u16 v23, v4 offset:16768
    ds_read_u16 v24, v4 offset:16896
    ds_read_u16 v25, v4 offset:17024
    ds_read_u16 v26, v4 offset:17152
    ds_read_u16 v27, v4 offset:17280
    ds_read_u16 v28, v4 offset:16416
    ds_read_u16 v29, v4 offset:16544
    ds_read_u16 v30, v4 offset:16672
    ds_read_u16 v31, v4 offset:16800
    ds_read_u16 v32, v4 offset:16928
    ds_read_u16 v33, v4 offset:17056
    ds_read_u16 v34, v4 offset:17184
    ds_read_u16 v35, v4 offset:17312
    ds_read_u16 v36, v4 offset:16448
    ds_read_u16 v37, v4 offset:16576
    ds_read_u16 v38, v4 offset:16704
    ds_read_u16 v39, v4 offset:16832
    ds_read_u16 v40, v4 offset:16960
    ds_read_u16 v41, v4 offset:17088
    ds_read_u16 v42, v4 offset:17216
    ds_read_u16 v43, v4 offset:17344
    ds_read_u16 v44, v4 offset:16480
    ds_read_u16 v45, v4 offset:16608
    ds_read_u16 v46, v4 offset:16736
    ds_read_u16 v47, v4 offset:16864
    ds_read_u16 v48, v4 offset:16992
    ds_read_u16 v49, v4 offset:17120
    ds_read_u16 v50, v4 offset:17248
    ds_read_u16 v51, v4 offset:17376
    s_waitcnt lgkmcnt(0)
    v_lshl_or_b32 v200, v21, 16, v20
    v_lshl_or_b32 v201, v23, 16, v22
    v_lshl_or_b32 v202, v25, 16, v24
    v_lshl_or_b32 v203, v27, 16, v26
    v_lshl_or_b32 v204, v29, 16, v28
    v_lshl_or_b32 v205, v31, 16, v30
    v_lshl_or_b32 v206, v33, 16, v32
    v_lshl_or_b32 v207, v35, 16, v34
    v_lshl_or_b32 v208, v37, 16, v36
    v_lshl_or_b32 v209, v39, 16, v38
    v_lshl_or_b32 v210, v41, 16, v40
    v_lshl_or_b32 v211, v43, 16, v42
    v_lshl_or_b32 v212, v45, 16, v44
    v_lshl_or_b32 v213, v47, 16, v46
    v_lshl_or_b32 v214, v49, 16, v48
    v_lshl_or_b32 v215, v51, 16, v50
    ds_write_b128 v19, v[216:219] offset:16384
    ds_write_b128 v19, v[220:223] offset:17408
    ds_write_b128 v19, v[224:227] offset:18432
    ds_write_b128 v19, v[228:231] offset:19456
    ds_read_u16 v20, v4 offset:16384
    ds_read_u16 v21, v4 offset:16512
    ds_read_u16 v22, v4 offset:16640
    ds_read_u16 v23, v4 offset:16768
    ds_read_u16 v24, v4 offset:16896
    ds_read_u16 v25, v4 offset:17024
    ds_read_u16 v26, v4 offset:17152
    ds_read_u16 v27, v4 offset:17280
    ds_read_u16 v28, v4 offset:16416
    ds_read_u16 v29, v4 offset:16544
    ds_read_u16 v30, v4 offset:16672
    ds_read_u16 v31, v4 offset:16800
    ds_read_u16 v32, v4 offset:16928
    ds_read_u16 v33, v4 offset:17056
    ds_read_u16 v34, v4 offset:17184
    ds_read_u16 v35, v4 offset:17312
    ds_read_u16 v36, v4 offset:16448
    ds_read_u16 v37, v4 offset:16576
    ds_read_u16 v38, v4 offset:16704
    ds_read_u16 v39, v4 offset:16832
    ds_read_u16 v40, v4 offset:16960
    ds_read_u16 v41, v4 offset:17088
    ds_read_u16 v42, v4 offset:17216
    ds_read_u16 v43, v4 offset:17344
    ds_read_u16 v44, v4 offset:16480
    ds_read_u16 v45, v4 offset:16608
    ds_read_u16 v46, v4 offset:16736
    ds_read_u16 v47, v4 offset:16864
    ds_read_u16 v48, v4 offset:16992
    ds_read_u16 v49, v4 offset:17120
    ds_read_u16 v50, v4 offset:17248
    ds_read_u16 v51, v4 offset:17376
    s_waitcnt lgkmcnt(0)
    v_lshl_or_b32 v216, v21, 16, v20
    v_lshl_or_b32 v217, v23, 16, v22
    v_lshl_or_b32 v218, v25, 16, v24
    v_lshl_or_b32 v219, v27, 16, v26
    v_lshl_or_b32 v220, v29, 16, v28
    v_lshl_or_b32 v221, v31, 16, v30
    v_lshl_or_b32 v222, v33, 16, v32
    v_lshl_or_b32 v223, v35, 16, v34
    v_lshl_or_b32 v224, v37, 16, v36
    v_lshl_or_b32 v225, v39, 16, v38
    v_lshl_or_b32 v226, v41, 16, v40
    v_lshl_or_b32 v227, v43, 16, v42
    v_lshl_or_b32 v228, v45, 16, v44
    v_lshl_or_b32 v229, v47, 16, v46
    v_lshl_or_b32 v230, v49, 16, v48
    v_lshl_or_b32 v231, v51, 16, v50
L_notM05:
    s_cmp_ge_u32 s5, 32
    s_cbranch_scc1 L_nored
    s_cmp_lg_u32 s3, 1
    s_cbranch_scc1 L_nored
    s_add_u32 s14, s5, 16
    s_mul_i32 s86, s14, 8320
    s_add_u32 s86, s86, 917504
    s_mul_i32 s89, s14, 640
    s_add_u32 s89, s89, 131072
    s_add_u32 s32, s86, 0
    s_add_u32 s33, s32, 4096
    s_mov_b32 s58, 0
    s_mov_b32 s15, 262144
LsgR_23_all:
    buffer_load_dwordx4 v[20:23], v1, s[60:63], s32 offen offset:0 sc1
    buffer_load_dwordx4 v[24:27], v1, s[60:63], s32 offen offset:1024 sc1
    buffer_load_dwordx4 v[28:31], v1, s[60:63], s32 offen offset:2048 sc1
    buffer_load_dwordx4 v[32:35], v1, s[60:63], s32 offen offset:3072 sc1
    buffer_load_dwordx4 v[36:39], v1, s[60:63], s33 offen offset:0 sc1
    buffer_load_dwordx4 v[40:43], v1, s[60:63], s33 offen offset:1024 sc1
    buffer_load_dwordx4 v[44:47], v1, s[60:63], s33 offen offset:2048 sc1
    buffer_load_dwordx4 v[48:51], v1, s[60:63], s33 offen offset:3072 sc1
    s_sub_u32 s15, s15, 1
    s_cbranch_scc1 L_end
    s_waitcnt vmcnt(0)
    s_mov_b32 s58, 0
    v_cmp_ne_u64 vcc, v[22:23], v[102:103]
    v_cmp_ne_u64 s[80:81], v[26:27], v[102:103]
    s_or_b64 vcc, vcc, s[80:81]
    s_cmp_lg_u64 vcc, 0
    s_cselect_b32 s14, 0x1, 0
    s_or_b32 s58, s58, s14
    v_cmp_ne_u64 vcc, v[30:31], v[102:103]
    v_cmp_ne_u64 s[80:81], v[34:35], v[102:103]
    s_or_b64 vcc, vcc, s[80:81]
    s_cmp_lg_u64 vcc, 0
    s_cselect_b32 s14, 0x2, 0
    s_or_b32 s58, s58, s14
    v_cmp_ne_u64 vcc, v[38:39], v[102:103]
    v_cmp_ne_u64 s[80:81], v[42:43], v[102:103]
    s_or_b64 vcc, vcc, s[80:81]
    s_cmp_lg_u64 vcc, 0
    s_cselect_b32 s14, 0x4, 0
    s_or_b32 s58, s58, s14
    v_cmp_ne_u64 vcc, v[46:47], v[102:103]
    v_cmp_ne_u64 s[80:81], v[50:51], v[102:103]
    s_or_b64 vcc, vcc, s[80:81]
    s_cmp_lg_u64 vcc, 0
    s_cselect_b32 s14, 0x8, 0
    s_or_b32 s58, s58, s14
    s_cmp_eq_u32 s58, 0
    s_cbranch_scc1 LsgR_23_done
LsgR_23:
    s_sleep 8
    s_bitcmp1_b32 s58, 0
    s_cbranch_scc1 LsgR_23_ld0
LsgR_23_ldr0:
    s_bitcmp1_b32 s58, 1
    s_cbranch_scc1 LsgR_23_ld1
LsgR_23_ldr1:
    s_bitcmp1_b32 s58, 2
    s_cbranch_scc1 LsgR_23_ld2
LsgR_23_ldr2:
    s_bitcmp1_b32 s58, 3
    s_cbranch_scc1 LsgR_23_ld3
LsgR_23_ldr3:
    s_sub_u32 s15, s15, 1
    s_cbranch_scc1 L_end
    s_waitcnt vmcnt(0)
    s_bitcmp1_b32 s58, 0
    s_cbranch_scc1 LsgR_23_ck0
LsgR_23_ckr0:
    s_bitcmp1_b32 s58, 1
    s_cbranch_scc1 LsgR_23_ck1
LsgR_23_ckr1:
    s_bitcmp1_b32 s58, 2
    s_cbranch_scc1 LsgR_23_ck2
LsgR_23_ckr2:
    s_bitcmp1_b32 s58, 3
    s_cbranch_scc1 LsgR_23_ck3
LsgR_23_ckr3:
    s_cmp_lg_u32 s58, 0
    s_cbranch_scc1 LsgR_23
    s_branch LsgR_23_done
LsgR_23_ld0:
    buffer_load_dwordx4 v[20:23], v1, s[60:63], s32 offen offset:0 sc1
    buffer_load_dwordx4 v[24:27], v1, s[60:63], s32 offen offset:1024 sc1
    s_branch LsgR_23_ldr0
LsgR_23_ck0:
    v_cmp_ne_u64 vcc, v[22:23], v[102:103]
    v_cmp_ne_u64 s[80:81], v[26:27], v[102:103]
    s_or_b64 vcc, vcc, s[80:81]
    s_nop 3
    s_cbranch_vccnz LsgR_23_ckr0
    s_bitset0_b32 s58, 0
    s_branch LsgR_23_ckr0
LsgR_23_ld1:
    buffer_load_dwordx4 v[28:31], v1, s[60:63], s32 offen offset:2048 sc1
    buffer_load_dwordx4 v[32:35], v1, s[60:63], s32 offen offset:3072 sc1
    s_branch LsgR_23_ldr1
LsgR_23_ck1:
    v_cmp_ne_u64 vcc, v[30:31], v[102:103]
    v_cmp_ne_u64 s[80:81], v[34:35], v[102:103]
    s_or_b64 vcc, vcc, s[80:81]
    s_nop 3
    s_cbranch_vccnz LsgR_23_ckr1
    s_bitset0_b32 s58, 1
    s_branch LsgR_23_ckr1
LsgR_23_ld2:
    buffer_load_dwordx4 v[36:39], v1, s[60:63], s33 offen offset:0 sc1
    buffer_load_dwordx4 v[40:43], v1, s[60:63], s33 offen offset:1024 sc1
    s_branch LsgR_23_ldr2
LsgR_23_ck2:
    v_cmp_ne_u64 vcc, v[38:39], v[102:103]
    v_cmp_ne_u64 s[80:81], v[42:43], v[102:103]
    s_or_b64 vcc, vcc, s[80:81]
    s_nop 3
    s_cbranch_vccnz LsgR_23_ckr2
    s_bitset0_b32 s58, 2
    s_branch LsgR_23_ckr2
LsgR_23_ld3:
    buffer_load_dwordx4 v[44:47], v1, s[60:63], s33 offen offset:2048 sc1
    buffer_load_dwordx4 v[48:51], v1, s[60:63], s33 offen offset:3072 sc1
    s_branch LsgR_23_ldr3
LsgR_23_ck3:
    v_cmp_ne_u64 vcc, v[46:47], v[102:103]
    v_cmp_ne_u64 s[80:81], v[50:51], v[102:103]
    s_or_b64 vcc, vcc, s[80:81]
    s_nop 3
    s_cbranch_vccnz LsgR_23_ckr3
    s_bitset0_b32 s58, 3
    s_branch LsgR_23_ckr3
LsgR_23_done:
    v_pk_add_f32 v[20:21], v[20:21], v[24:25]
    v_pk_add_f32 v[20:21], v[20:21], v[28:29]
    v_pk_add_f32 v[20:21], v[20:21], v[32:33]
    v_pk_add_f32 v[20:21], v[20:21], v[36:37]
    v_pk_add_f32 v[20:21], v[20:21], v[40:41]
    v_pk_add_f32 v[20:21], v[20:21], v[44:45]
    v_pk_add_f32 v[20:21], v[20:21], v[48:49]
    v_mov_b32 v232, v20
    v_mov_b32 v233, v21
    v_mov_b32 v28, v232
    v_mov_b32 v29, v233
    s_nop 0
    v_permlane32_swap_b32 v232, v28
    v_permlane32_swap_b32 v233, v29
    v_add_f32 v232, v232, v28
    v_add_f32 v233, v233, v29
    v_cvt_pk_bf16_f32 v24, v232, v233
    v_lshlrev_b32 v232, 16, v24
    v_and_b32 v233, s83, v24
    v_mov_b32 v234, s96
    v_mov_b32 v235, s97
    s_mov_b32 exec_lo, -1
    s_mov_b32 exec_hi, 0
    buffer_store_dwordx4 v[232:235], v1, s[60:63], s89 offen sc1
    s_mov_b64 exec, -1
L_nored:
    s_cmp_lg_u32 s3, 0
    s_cbranch_scc1 L_gow
    s_mov_b32 s15, 262144
    s_mov_b32 exec_lo, 1
    s_mov_b32 exec_hi, 0
L_go:
    s_sleep 64
    buffer_load_dword v80, v2, s[64:67], 0 offen offset:128 sc1
    s_sub_u32 s15, s15, 1
    s_cbranch_scc1 L_end
    s_waitcnt vmcnt(0)
    v_readfirstlane_b32 s14, v80
    s_cmp_eq_u32 s14, 0
    s_nop 3
    s_cbranch_scc1 L_go
    ds_add_u32 v2, v3 offset:28
    s_mov_b64 exec, -1
L_gow:
    s_mov_b32 s15, 4194304
Lw_24:
    ds_read_b32 v80, v2 offset:28
    s_sub_u32 s15, s15, 1
    s_cbranch_scc1 L_end
    s_waitcnt lgkmcnt(0)
    v_readfirstlane_b32 s14, v80
    s_cmp_ge_u32 s14, 1
    s_cbranch_scc1 Lwd_25
    s_sleep 8
    s_nop 1
    s_branch Lw_24
Lwd_25:
    s_cmp_eq_u32 s8, 0
    s_cbranch_scc1 L_notM1
    v_lshlrev_b32 v56, 16, v98
    v_and_b32 v57, s83, v98
    v_lshlrev_b32 v58, 16, v99
    v_and_b32 v59, s83, v99
    v_and_b32 v4, 15, v0
    v_lshlrev_b32 v4, 5, v4
    v_bfe_u32 v6, v0, 4, 1
    v_mul_u32_u24 v6, 640, v6
    v_add_u32 v4, v4, v6
    v_and_b32 v6, 3, v0
    v_lshlrev_b32 v6, 5, v6
    s_mul_i32 s32, s3, 1280
    s_add_u32 s32, s32, 141312
    s_add_u32 s33, s32, 5120
    s_add_u32 s34, s32, 10240
    s_mul_i32 s35, s4, 640
    s_lshl_b32 s12, s3, 7
    s_add_u32 s35, s35, s12
    s_add_u32 s35, s35, 156672
    s_mov_b32 s58, 0
    s_mov_b32 s15, 262144
LsgMF_26_all:
    buffer_load_dwordx4 v[20:23], v4, s[60:63], s32 offen sc1
    buffer_load_dwordx4 v[24:27], v4, s[60:63], s32 offen offset:16 sc1
    buffer_load_dwordx4 v[28:31], v4, s[60:63], s33 offen sc1
    buffer_load_dwordx4 v[32:35], v4, s[60:63], s33 offen offset:16 sc1
    buffer_load_dwordx4 v[36:39], v4, s[60:63], s34 offen sc1
    buffer_load_dwordx4 v[40:43], v4, s[60:63], s34 offen offset:16 sc1
    buffer_load_dwordx4 v[44:47], v6, s[60:63], s35 offen sc1
    buffer_load_dwordx4 v[48:51], v6, s[60:63], s35 offen offset:16 sc1
    s_sub_u32 s15, s15, 1
    s_cbranch_scc1 L_end
    s_waitcnt vmcnt(0)
    s_mov_b32 s58, 0
    v_cmp_ne_u64 vcc, v[22:23], v[102:103]
    v_cmp_ne_u64 s[80:81], v[26:27], v[102:103]
    s_or_b64 vcc, vcc, s[80:81]
    s_cmp_lg_u64 vcc, 0
    s_cselect_b32 s14, 0x1, 0
    s_or_b32 s58, s58, s14
    v_cmp_ne_u64 vcc, v[30:31], v[102:103]
    v_cmp_ne_u64 s[80:81], v[34:35], v[102:103]
    s_or_b64 vcc, vcc, s[80:81]
    s_cmp_lg_u64 vcc, 0
    s_cselect_b32 s14, 0x2, 0
    s_or_b32 s58, s58, s14
    v_cmp_ne_u64 vcc, v[38:39], v[102:103]
    v_cmp_ne_u64 s[80:81], v[42:43], v[102:103]
    s_or_b64 vcc, vcc, s[80:81]
    s_cmp_lg_u64 vcc, 0
    s_cselect_b32 s14, 0x4, 0
    s_or_b32 s58, s58, s14
    v_cmp_ne_u64 vcc, v[46:47], v[102:103]
    v_cmp_ne_u64 s[80:81], v[50:51], v[102:103]
    s_or_b64 vcc, vcc, s[80:81]
    s_cmp_lg_u64 vcc, 0
    s_cselect_b32 s14, 0x8, 0
    s_or_b32 s58, s58, s14
    s_cmp_eq_u32 s58, 0
    s_cbranch_scc1 LsgMF_26_done
LsgMF_26:
    s_sleep 16
    s_bitcmp1_b32 s58, 0
    s_cbranch_scc1 LsgMF_26_ld0
LsgMF_26_ldr0:
    s_bitcmp1_b32 s58, 1
    s_cbranch_scc1 LsgMF_26_ld1
LsgMF_26_ldr1:
    s_bitcmp1_b32 s58, 2
    s_cbranch_scc1 LsgMF_26_ld2
LsgMF_26_ldr2:
    s_bitcmp1_b32 s58, 3
    s_cbranch_scc1 LsgMF_26_ld3
LsgMF_26_ldr3:
    s_sub_u32 s15, s15, 1
    s_cbranch_scc1 L_end
    s_waitcnt vmcnt(0)
    s_bitcmp1_b32 s58, 0
    s_cbranch_scc1 LsgMF_26_ck0
LsgMF_26_ckr0:
    s_bitcmp1_b32 s58, 1
    s_cbranch_scc1 LsgMF_26_ck1
LsgMF_26_ckr1:
    s_bitcmp1_b32 s58, 2
    s_cbranch_scc1 LsgMF_26_ck2
LsgMF_26_ckr2:
    s_bitcmp1_b32 s58, 3
    s_cbranch_scc1 LsgMF_26_ck3
LsgMF_26_ckr3:
    s_cmp_lg_u32 s58, 0
    s_cbranch_scc1 LsgMF_26
    s_branch LsgMF_26_done
LsgMF_26_ld0:
    buffer_load_dwordx4 v[20:23], v4, s[60:63], s32 offen sc1
    buffer_load_dwordx4 v[24:27], v4, s[60:63], s32 offen offset:16 sc1
    s_branch LsgMF_26_ldr0
LsgMF_26_ck0:
    v_cmp_ne_u64 vcc, v[22:23], v[102:103]
    v_cmp_ne_u64 s[80:81], v[26:27], v[102:103]
    s_or_b64 vcc, vcc, s[80:81]
    s_nop 3
    s_cbranch_vccnz LsgMF_26_ckr0
    s_bitset0_b32 s58, 0
    s_branch LsgMF_26_ckr0
LsgMF_26_ld1:
    buffer_load_dwordx4 v[28:31], v4, s[60:63], s33 offen sc1
    buffer_load_dwordx4 v[32:35], v4, s[60:63], s33 offen offset:16 sc1
    s_branch LsgMF_26_ldr1
LsgMF_26_ck1:
    v_cmp_ne_u64 vcc, v[30:31], v[102:103]
    v_cmp_ne_u64 s[80:81], v[34:35], v[102:103]
    s_or_b64 vcc, vcc, s[80:81]
    s_nop 3
    s_cbranch_vccnz LsgMF_26_ckr1
    s_bitset0_b32 s58, 1
    s_branch LsgMF_26_ckr1
LsgMF_26_ld2:
    buffer_load_dwordx4 v[36:39], v4, s[60:63], s34 offen sc1
    buffer_load_dwordx4 v[40:43], v4, s[60:63], s34 offen offset:16 sc1
    s_branch LsgMF_26_ldr2
LsgMF_26_ck2:
    v_cmp_ne_u64 vcc, v[38:39], v[102:103]
    v_cmp_ne_u64 s[80:81], v[42:43], v[102:103]
    s_or_b64 vcc, vcc, s[80:81]
    s_nop 3
    s_cbranch_vccnz LsgMF_26_ckr2
    s_bitset0_b32 s58, 2
    s_branch LsgMF_26_ckr2
LsgMF_26_ld3:
    buffer_load_dwordx4 v[44:47], v6, s[60:63], s35 offen sc1
    buffer_load_dwordx4 v[48:51], v6, s[60:63], s35 offen offset:16 sc1
    s_branch LsgMF_26_ldr3
LsgMF_26_ck3:
    v_cmp_ne_u64 vcc, v[46:47], v[102:103]
    v_cmp_ne_u64 s[80:81], v[50:51], v[102:103]
    s_or_b64 vcc, vcc, s[80:81]
    s_nop 3
    s_cbranch_vccnz LsgMF_26_ckr3
    s_bitset0_b32 s58, 3
    s_branch LsgMF_26_ckr3
LsgMF_26_done:
    v_mov_b32 v52, v20
    v_mov_b32 v53, v21
    v_mov_b32 v54, v24
    v_mov_b32 v55, v25
    v_mov_b32 v64, v28
    v_mov_b32 v65, v29
    v_mov_b32 v66, v32
    v_mov_b32 v67, v33
    v_mov_b32 v60, v36
    v_mov_b32 v61, v37
    v_mov_b32 v62, v40
    v_mov_b32 v63, v41
    v_mov_b32 v240, v44
    v_mov_b32 v241, v45
    v_mov_b32 v242, v48
    v_mov_b32 v243, v49
    v_add_f32 v60, 1.0, v60
    v_add_f32 v61, 1.0, v61
    v_add_f32 v62, 1.0, v62
    v_add_f32 v63, 1.0, v63
    v_cvt_pk_bf16_f32 v80, v60, v61
    v_cvt_pk_bf16_f32 v81, v62, v63
    v_lshlrev_b32 v60, 16, v80
    v_and_b32 v61, s83, v80
    v_lshlrev_b32 v62, 16, v81
    v_and_b32 v63, s83, v81
L_notM1:
    v_lshrrev_b32 v18, 5, v0
    v_and_b32 v7, 31, v0
    v_lshlrev_b32 v7, 4, v7
    v_lshl_add_u32 v7, v18, 11, v7
    v_lshrrev_b32 v8, 3, v0
    v_mul_u32_u24 v9, 640, v8
    v_and_b32 v10, 7, v0
    v_lshl_add_u32 v8, v10, 4, v9
    s_lshl_b32 s13, s3, 7
    v_add_u32 v8, s13, v8
    s_lshl_b32 s12, s3, 6
    v_lshl_add_u32 v10, v0, 3, s12
    v_add_u32 v11, s12, v17
    v_and_b32 v12, 15, v0
    v_lshl_add_u32 v12, v12, 6, v17
    s_lshl_b32 s12, s3, 8
    v_add_u32 v13, s12, v1
    v_add_u32 v6, s12, v17
    v_lshl_add_u32 v14, v0, 3, s12
    s_lshl_b32 s12, s3, 3
    v_mov_b32 v15, s12
    s_lshl_b32 s12, s3, 7
    v_add_u32 v16, s12, v17
    v_lshlrev_b32 v4, 1, v17
    s_mul_i32 s32, s6, 15360
    s_add_u32 s32, s32, 196608
    s_add_u32 s33, s32, 5120
    s_add_u32 s34, s32, 10240
    s_lshl_b32 s56, s3, 9
    s_add_u32 s56, s56, 720896
    s_lshl_b32 s57, s4, 8
    s_lshl_b32 s13, s3, 6
    s_add_u32 s57, s57, s13
    s_add_u32 s57, s57, 786432
    s_mov_b32 s58, 0
    s_mov_b32 s15, 262144
LsgW_27_all:
    buffer_load_dwordx4 v[20:23], v8, s[60:63], s32 offen sc1
    buffer_load_dword v32, v9, s[60:63], s32 offen offset:512 sc1
    buffer_load_dwordx4 v[24:27], v8, s[60:63], s33 offen sc1
    buffer_load_dword v33, v9, s[60:63], s33 offen offset:512 sc1
    buffer_load_dwordx4 v[28:31], v8, s[60:63], s34 offen sc1
    buffer_load_dword v34, v9, s[60:63], s34 offen offset:512 sc1
    s_sub_u32 s15, s15, 1
    s_cbranch_scc1 L_end
    s_waitcnt vmcnt(0)
    s_mov_b32 s58, 0
    v_max3_u32 v80, v20, v21, v22
    v_max3_u32 v80, v80, v23, v32
    v_cmp_eq_u32 vcc, -1, v80
    s_cmp_lg_u64 vcc, 0
    s_cselect_b32 s14, 0x1, 0
    s_or_b32 s58, s58, s14
    v_max3_u32 v80, v24, v25, v26
    v_max3_u32 v80, v80, v27, v33
    v_cmp_eq_u32 vcc, -1, v80
    s_cmp_lg_u64 vcc, 0
    s_cselect_b32 s14, 0x2, 0
    s_or_b32 s58, s58, s14
    v_max3_u32 v80, v28, v29, v30
    v_max3_u32 v80, v80, v31, v34
    v_cmp_eq_u32 vcc, -1, v80
    s_cmp_lg_u64 vcc, 0
    s_cselect_b32 s14, 0x4, 0
    s_or_b32 s58, s58, s14
    s_cmp_eq_u32 s58, 0
    s_cbranch_scc1 LsgW_27_done
    s_cmp_lg_u32 s58, 0x7
    s_cbranch_scc1 LsgW_27
    s_sleep 40
    s_branch LsgW_27_all
LsgW_27:
    s_bitcmp1_b32 s58, 0
    s_cbranch_scc1 LsgW_27_ld0
LsgW_27_ldr0:
    s_bitcmp1_b32 s58, 1
    s_cbranch_scc1 LsgW_27_ld1
LsgW_27_ldr1:
    s_bitcmp1_b32 s58, 2
    s_cbranch_scc1 LsgW_27_ld2
LsgW_27_ldr2:
    s_sub_u32 s15, s15, 1
    s_cbranch_scc1 L_end
    s_waitcnt vmcnt(0)
    s_bitcmp1_b32 s58, 0
    s_cbranch_scc1 LsgW_27_ck0
LsgW_27_ckr0:
    s_bitcmp1_b32 s58, 1
    s_cbranch_scc1 LsgW_27_ck1
LsgW_27_ckr1:
    s_bitcmp1_b32 s58, 2
    s_cbranch_scc1 LsgW_27_ck2
LsgW_27_ckr2:
    s_cmp_lg_u32 s58, 0
    s_cbranch_scc1 LsgW_27
    s_branch LsgW_27_done
LsgW_27_ld0:
    buffer_load_dwordx4 v[20:23], v8, s[60:63], s32 offen sc1
    buffer_load_dword v32, v9, s[60:63], s32 offen offset:512 sc1
    s_branch LsgW_27_ldr0
LsgW_27_ck0:
    v_max3_u32 v80, v20, v21, v22
    v_max3_u32 v80, v80, v23, v32
    v_cmp_eq_u32 vcc, -1, v80
    s_nop 4
    s_cbranch_vccnz LsgW_27_ckr0
    s_bitset0_b32 s58, 0
    s_branch LsgW_27_ckr0
LsgW_27_ld1:
    buffer_load_dwordx4 v[24:27], v8, s[60:63], s33 offen sc1
    buffer_load_dword v33, v9, s[60:63], s33 offen offset:512 sc1
    s_branch LsgW_27_ldr1
LsgW_27_ck1:
    v_max3_u32 v80, v24, v25, v26
    v_max3_u32 v80, v80, v27, v33
    v_cmp_eq_u32 vcc, -1, v80
    s_nop 4
    s_cbranch_vccnz LsgW_27_ckr1
    s_bitset0_b32 s58, 1
    s_branch LsgW_27_ckr1
LsgW_27_ld2:
    buffer_load_dwordx4 v[28:31], v8, s[60:63], s34 offen sc1
    buffer_load_dword v34, v9, s[60:63], s34 offen offset:512 sc1
    s_branch LsgW_27_ldr2
LsgW_27_ck2:
    v_max3_u32 v80, v28, v29, v30
    v_max3_u32 v80, v80, v31, v34
    v_cmp_eq_u32 vcc, -1, v80
    s_nop 4
    s_cbranch_vccnz LsgW_27_ckr2
    s_bitset0_b32 s58, 2
    s_branch LsgW_27_ckr2
LsgW_27_done:
    v_max3_f32 v36, v32, v33, v34
    s_nop 1
    v_max_f32 v36, v36, v36 row_ror:8
    v_mov_b32 v37, v36
    s_nop 1
    v_permlane16_swap_b32 v36, v37
    v_max_f32 v36, v36, v37
    v_mov_b32 v37, v36
    s_nop 1
    v_permlane32_swap_b32 v36, v37
    v_max_f32 v36, v36, v37
    v_sub_f32 v32, v32, v36
    v_sub_f32 v33, v33, v36
    v_sub_f32 v34, v34, v36
    v_exp_f32 v32, v32
    v_exp_f32 v33, v33
    v_exp_f32 v34, v34
    v_mul_f32 v20, v20, v32
    v_mul_f32 v21, v21, v32
    v_mul_f32 v22, v22, v32
    v_mul_f32 v23, v23, v32
    v_fmac_f32 v20, v24, v33
    v_fmac_f32 v21, v25, v33
    v_fmac_f32 v22, v26, v33
    v_fmac_f32 v23, v27, v33
    v_fmac_f32 v20, v28, v34
    v_fmac_f32 v21, v29, v34
    v_fmac_f32 v22, v30, v34
    v_fmac_f32 v23, v31, v34
    v_add_f32 v24, v32, v33
    v_add_f32 v24, v24, v34
    v_add_f32 v20, v20, v20 row_ror:8
    v_add_f32 v21, v21, v21 row_ror:8
    v_add_f32 v22, v22, v22 row_ror:8
    v_add_f32 v23, v23, v23 row_ror:8
    v_add_f32 v24, v24, v24 row_ror:8
    v_mov_b32 v28, v20
    v_mov_b32 v29, v21
    v_mov_b32 v30, v22
    v_mov_b32 v31, v23
    v_mov_b32 v32, v24
    v_permlane16_swap_b32 v20, v28
    v_permlane16_swap_b32 v21, v29
    v_permlane16_swap_b32 v22, v30
    v_permlane16_swap_b32 v23, v31
    v_permlane16_swap_b32 v24, v32
    v_add_f32 v20, v20, v28
    v_add_f32 v21, v21, v29
    v_add_f32 v22, v22, v30
    v_add_f32 v23, v23, v31
    v_add_f32 v24, v24, v32
    v_mov_b32 v28, v20
    v_mov_b32 v29, v21
    v_mov_b32 v30, v22
    v_mov_b32 v31, v23
    v_mov_b32 v32, v24
    v_permlane32_swap_b32 v20, v28
    v_permlane32_swap_b32 v21, v29
    v_permlane32_swap_b32 v22, v30
    v_permlane32_swap_b32 v23, v31
    v_permlane32_swap_b32 v24, v32
    v_add_f32 v20, v20, v28
    v_add_f32 v21, v21, v29
    v_add_f32 v22, v22, v30
    v_add_f32 v23, v23, v31
    v_add_f32 v24, v24, v32
    v_rcp_f32 v24, v24
    s_nop 0
    v_mul_f32 v20, v20, v24
    v_mul_f32 v21, v21, v24
    v_mul_f32 v22, v22, v24
    v_mul_f32 v23, v23, v24
    v_cvt_pk_bf16_f32 v26, v20, v21
    v_cvt_pk_bf16_f32 v27, v22, v23
    s_mov_b32 exec_lo, 0xff
    s_mov_b32 exec_hi, 0
    ds_write_b64 v10, v[26:27] offset:2688
    s_mov_b64 exec, -1
    s_waitcnt lgkmcnt(0)
    s_mov_b32 exec_lo, 1
    s_mov_b32 exec_hi, 0
    ds_add_u32 v2, v3 offset:12
    s_mov_b64 exec, -1
    s_mov_b32 s15, 4194304
Lw_28:
    ds_read_b32 v80, v2 offset:12
    s_sub_u32 s15, s15, 1
    s_cbranch_scc1 L_end
    s_waitcnt lgkmcnt(0)
    v_readfirstlane_b32 s14, v80
    s_cmp_ge_u32 s14, 4
    s_nop 3
    s_cbranch_scc0 Lw_28
    ds_read_b128 v[36:39], v17 offset:2688
    ds_read_b128 v[40:43], v17 offset:2752
    ds_read_b128 v[44:47], v17 offset:2816
    ds_read_b128 v[48:51], v17 offset:2880
    s_waitcnt lgkmcnt(3)
    v_mfma_f32_16x16x32_bf16 v[20:23], v[104:107], v[36:39], 0
    v_mfma_f32_16x16x32_bf16 v[24:27], v[108:111], v[36:39], 0
    v_mfma_f32_16x16x32_bf16 v[28:31], v[112:115], v[36:39], 0
    v_mfma_f32_16x16x32_bf16 v[32:35], v[116:119], v[36:39], 0
    s_waitcnt lgkmcnt(2)
    v_mfma_f32_16x16x32_bf16 v[20:23], v[120:123], v[40:43], v[20:23]
    v_mfma_f32_16x16x32_bf16 v[24:27], v[124:127], v[40:43], v[24:27]
    v_mfma_f32_16x16x32_bf16 v[28:31], v[128:131], v[40:43], v[28:31]
    v_mfma_f32_16x16x32_bf16 v[32:35], v[132:135], v[40:43], v[32:35]
    s_waitcnt lgkmcnt(1)
    v_mfma_f32_16x16x32_bf16 v[20:23], v[136:139], v[44:47], v[20:23]
    v_mfma_f32_16x16x32_bf16 v[24:27], v[140:143], v[44:47], v[24:27]
    v_mfma_f32_16x16x32_bf16 v[28:31], v[144:147], v[44:47], v[28:31]
    v_mfma_f32_16x16x32_bf16 v[32:35], v[148:151], v[44:47], v[32:35]
    s_waitcnt lgkmcnt(0)
    v_mfma_f32_16x16x32_bf16 v[20:23], v[152:155], v[48:51], v[20:23]
    v_mfma_f32_16x16x32_bf16 v[24:27], v[156:159], v[48:51], v[24:27]
    v_mfma_f32_16x16x32_bf16 v[28:31], v[160:163], v[48:51], v[28:31]
    v_mfma_f32_16x16x32_bf16 v[32:35], v[164:167], v[48:51], v[32:35]
    s_mov_b32 exec_lo, 0x00010001
    s_mov_b32 exec_hi, 0x00010001
    s_nop 2
    buffer_store_dwordx4 v[20:23], v17, s[60:63], s87 offen offset:0 sc1
    buffer_store_dwordx4 v[24:27], v17, s[60:63], s87 offen offset:64 sc1
    buffer_store_dwordx4 v[28:31], v17, s[60:63], s87 offen offset:128 sc1
    buffer_store_dwordx4 v[32:35], v17, s[60:63], s87 offen offset:192 sc1
    s_mov_b64 exec, -1
    s_cmp_eq_u32 s8, 0
    s_cbranch_scc1 L_end
    s_mov_b32 s58, 0
    s_mov_b32 s15, 262144
LsgY_30_all:
    s_add_u32 s12, s56, 0
    buffer_load_dwordx4 v[104:107], v7, s[60:63], s12 offen sc1
    s_add_u32 s12, s56, 4096
    buffer_load_dwordx4 v[108:111], v7, s[60:63], s12 offen sc1
    s_add_u32 s12, s56, 8192
    buffer_load_dwordx4 v[112:115], v7, s[60:63], s12 offen sc1
    s_add_u32 s12, s56, 12288
    buffer_load_dwordx4 v[116:119], v7, s[60:63], s12 offen sc1
    s_add_u32 s12, s56, 16384
    buffer_load_dwordx4 v[120:123], v7, s[60:63], s12 offen sc1
    s_add_u32 s12, s56, 20480
    buffer_load_dwordx4 v[124:127], v7, s[60:63], s12 offen sc1
    s_add_u32 s12, s56, 24576
    buffer_load_dwordx4 v[128:131], v7, s[60:63], s12 offen sc1
    s_add_u32 s12, s56, 28672
    buffer_load_dwordx4 v[132:135], v7, s[60:63], s12 offen sc1
    s_add_u32 s12, s56, 32768
    buffer_load_dwordx4 v[136:139], v7, s[60:63], s12 offen sc1
    s_add_u32 s12, s56, 36864
    buffer_load_dwordx4 v[140:143], v7, s[60:63], s12 offen sc1
    s_add_u32 s12, s56, 40960
    buffer_load_dwordx4 v[144:147], v7, s[60:63], s12 offen sc1
    s_add_u32 s12, s56, 45056
    buffer_load_dwordx4 v[148:151], v7, s[60:63], s12 offen sc1
    s_add_u32 s12, s56, 49152
    buffer_load_dwordx4 v[152:155], v7, s[60:63], s12 offen sc1
    s_add_u32 s12, s56, 53248
    buffer_load_dwordx4 v[156:159], v7, s[60:63], s12 offen sc1
    s_add_u32 s12, s56, 57344
    buffer_load_dwordx4 v[160:163], v7, s[60:63], s12 offen sc1
    s_add_u32 s12, s56, 61440
    buffer_load_dwordx4 v[164:167], v7, s[60:63], s12 offen sc1
    s_sub_u32 s15, s15, 1
    s_cbranch_scc1 L_end
    s_waitcnt vmcnt(0)
    s_mov_b32 s58, 0
    v_max3_u32 v80, v104, v105, v106
    v_max_u32 v80, v80, v107
    v_cmp_eq_u32 vcc, -1, v80
    s_cmp_lg_u64 vcc, 0
    s_cselect_b32 s14, 0x1, 0
    s_or_b32 s58, s58, s14
    v_max3_u32 v80, v108, v109, v110
    v_max_u32 v80, v80, v111
    v_cmp_eq_u32 vcc, -1, v80
    s_cmp_lg_u64 vcc, 0
    s_cselect_b32 s14, 0x2, 0
    s_or_b32 s58, s58, s14
    v_max3_u32 v80, v112, v113, v114
    v_max_u32 v80, v80, v115
    v_cmp_eq_u32 vcc, -1, v80
    s_cmp_lg_u64 vcc, 0
    s_cselect_b32 s14, 0x4, 0
    s_or_b32 s58, s58, s14
    v_max3_u32 v80, v116, v117, v118
    v_max_u32 v80, v80, v119
    v_cmp_eq_u32 vcc, -1, v80
    s_cmp_lg_u64 vcc, 0
    s_cselect_b32 s14, 0x8, 0
    s_or_b32 s58, s58, s14
    v_max3_u32 v80, v120, v121, v122
    v_max_u32 v80, v80, v123
    v_cmp_eq_u32 vcc, -1, v80
    s_cmp_lg_u64 vcc, 0
    s_cselect_b32 s14, 0x10, 0
    s_or_b32 s58, s58, s14
    v_max3_u32 v80, v124, v125, v126
    v_max_u32 v80, v80, v127
    v_cmp_eq_u32 vcc, -1, v80
    s_cmp_lg_u64 vcc, 0
    s_cselect_b32 s14, 0x20, 0
    s_or_b32 s58, s58, s14
    v_max3_u32 v80, v128, v129, v130
    v_max_u32 v80, v80, v131
    v_cmp_eq_u32 vcc, -1, v80
    s_cmp_lg_u64 vcc, 0
    s_cselect_b32 s14, 0x40, 0
    s_or_b32 s58, s58, s14
    v_max3_u32 v80, v132, v133, v134
    v_max_u32 v80, v80, v135
    v_cmp_eq_u32 vcc, -1, v80
    s_cmp_lg_u64 vcc, 0
    s_cselect_b32 s14, 0x80, 0
    s_or_b32 s58, s58, s14
    v_max3_u32 v80, v136, v137, v138
    v_max_u32 v80, v80, v139
    v_cmp_eq_u32 vcc, -1, v80
    s_cmp_lg_u64 vcc, 0
    s_cselect_b32 s14, 0x100, 0
    s_or_b32 s58, s58, s14
    v_max3_u32 v80, v140, v141, v142
    v_max_u32 v80, v80, v143
    v_cmp_eq_u32 vcc, -1, v80
    s_cmp_lg_u64 vcc, 0
    s_cselect_b32 s14, 0x200, 0
    s_or_b32 s58, s58, s14
    v_max3_u32 v80, v144, v145, v146
    v_max_u32 v80, v80, v147
    v_cmp_eq_u32 vcc, -1, v80
    s_cmp_lg_u64 vcc, 0
    s_cselect_b32 s14, 0x400, 0
    s_or_b32 s58, s58, s14
    v_max3_u32 v80, v148, v149, v150
    v_max_u32 v80, v80, v151
    v_cmp_eq_u32 vcc, -1, v80
    s_cmp_lg_u64 vcc, 0
    s_cselect_b32 s14, 0x800, 0
    s_or_b32 s58, s58, s14
    v_max3_u32 v80, v152, v153, v154
    v_max_u32 v80, v80, v155
    v_cmp_eq_u32 vcc, -1, v80
    s_cmp_lg_u64 vcc, 0
    s_cselect_b32 s14, 0x1000, 0
    s_or_b32 s58, s58, s14
    v_max3_u32 v80, v156, v157, v158
    v_max_u32 v80, v80, v159
    v_cmp_eq_u32 vcc, -1, v80
    s_cmp_lg_u64 vcc, 0
    s_cselect_b32 s14, 0x2000, 0
    s_or_b32 s58, s58, s14
    v_max3_u32 v80, v160, v161, v162
    v_max_u32 v80, v80, v163
    v_cmp_eq_u32 vcc, -1, v80
    s_cmp_lg_u64 vcc, 0
    s_cselect_b32 s14, 0x4000, 0
    s_or_b32 s58, s58, s14
    v_max3_u32 v80, v164, v165, v166
    v_max_u32 v80, v80, v167
    v_cmp_eq_u32 vcc, -1, v80
    s_cmp_lg_u64 vcc, 0
    s_cselect_b32 s14, 0x8000, 0
    s_or_b32 s58, s58, s14
    s_cmp_eq_u32 s58, 0
    s_cbranch_scc1 LsgY_30_done
LsgY_30:
    s_bitcmp1_b32 s58, 0
    s_cbranch_scc1 LsgY_30_ld0
LsgY_30_ldr0:
    s_bitcmp1_b32 s58, 1
    s_cbranch_scc1 LsgY_30_ld1
LsgY_30_ldr1:
    s_bitcmp1_b32 s58, 2
    s_cbranch_scc1 LsgY_30_ld2
LsgY_30_ldr2:
    s_bitcmp1_b32 s58, 3
    s_cbranch_scc1 LsgY_30_ld3
LsgY_30_ldr3:
    s_bitcmp1_b32 s58, 4
    s_cbranch_scc1 LsgY_30_ld4
LsgY_30_ldr4:
    s_bitcmp1_b32 s58, 5
    s_cbranch_scc1 LsgY_30_ld5
LsgY_30_ldr5:
    s_bitcmp1_b32 s58, 6
    s_cbranch_scc1 LsgY_30_ld6
LsgY_30_ldr6:
    s_bitcmp1_b32 s58, 7
    s_cbranch_scc1 LsgY_30_ld7
LsgY_30_ldr7:
    s_bitcmp1_b32 s58, 8
    s_cbranch_scc1 LsgY_30_ld8
LsgY_30_ldr8:
    s_bitcmp1_b32 s58, 9
    s_cbranch_scc1 LsgY_30_ld9
LsgY_30_ldr9:
    s_bitcmp1_b32 s58, 10
    s_cbranch_scc1 LsgY_30_ld10
LsgY_30_ldr10:
    s_bitcmp1_b32 s58, 11
    s_cbranch_scc1 LsgY_30_ld11
LsgY_30_ldr11:
    s_bitcmp1_b32 s58, 12
    s_cbranch_scc1 LsgY_30_ld12
LsgY_30_ldr12:
    s_bitcmp1_b32 s58, 13
    s_cbranch_scc1 LsgY_30_ld13
LsgY_30_ldr13:
    s_bitcmp1_b32 s58, 14
    s_cbranch_scc1 LsgY_30_ld14
LsgY_30_ldr14:
    s_bitcmp1_b32 s58, 15
    s_cbranch_scc1 LsgY_30_ld15
LsgY_30_ldr15:
    s_sub_u32 s15, s15, 1
    s_cbranch_scc1 L_end
    s_waitcnt vmcnt(0)
    s_bitcmp1_b32 s58, 0
    s_cbranch_scc1 LsgY_30_ck0
LsgY_30_ckr0:
    s_bitcmp1_b32 s58, 1
    s_cbranch_scc1 LsgY_30_ck1
LsgY_30_ckr1:
    s_bitcmp1_b32 s58, 2
    s_cbranch_scc1 LsgY_30_ck2
LsgY_30_ckr2:
    s_bitcmp1_b32 s58, 3
    s_cbranch_scc1 LsgY_30_ck3
LsgY_30_ckr3:
    s_bitcmp1_b32 s58, 4
    s_cbranch_scc1 LsgY_30_ck4
LsgY_30_ckr4:
    s_bitcmp1_b32 s58, 5
    s_cbranch_scc1 LsgY_30_ck5
LsgY_30_ckr5:
    s_bitcmp1_b32 s58, 6
    s_cbranch_scc1 LsgY_30_ck6
LsgY_30_ckr6:
    s_bitcmp1_b32 s58, 7
    s_cbranch_scc1 LsgY_30_ck7
LsgY_30_ckr7:
    s_bitcmp1_b32 s58, 8
    s_cbranch_scc1 LsgY_30_ck8
LsgY_30_ckr8:
    s_bitcmp1_b32 s58, 9
    s_cbranch_scc1 LsgY_30_ck9
LsgY_30_ckr9:
    s_bitcmp1_b32 s58, 10
    s_cbranch_scc1 LsgY_30_ck10
LsgY_30_ckr10:
    s_bitcmp1_b32 s58, 11
    s_cbranch_scc1 LsgY_30_ck11
LsgY_30_ckr11:
    s_bitcmp1_b32 s58, 12
    s_cbranch_scc1 LsgY_30_ck12
LsgY_30_ckr12:
    s_bitcmp1_b32 s58, 13
    s_cbranch_scc1 LsgY_30_ck13
LsgY_30_ckr13:
    s_bitcmp1_b32 s58, 14
    s_cbranch_scc1 LsgY_30_ck14
LsgY_30_ckr14:
    s_bitcmp1_b32 s58, 15
    s_cbranch_scc1 LsgY_30_ck15
LsgY_30_ckr15:
    s_cmp_lg_u32 s58, 0
    s_cbranch_scc1 LsgY_30
    s_branch LsgY_30_done
LsgY_30_ld0:
    s_add_u32 s12, s56, 0
    buffer_load_dwordx4 v[104:107], v7, s[60:63], s12 offen sc1
    s_branch LsgY_30_ldr0
LsgY_30_ck0:
    v_max3_u32 v80, v104, v105, v106
    v_max_u32 v80, v80, v107
    v_cmp_eq_u32 vcc, -1, v80
    s_nop 4
    s_cbranch_vccnz LsgY_30_ckr0
    s_bitset0_b32 s58, 0
    s_branch LsgY_30_ckr0
LsgY_30_ld1:
    s_add_u32 s12, s56, 4096
    buffer_load_dwordx4 v[108:111], v7, s[60:63], s12 offen sc1
    s_branch LsgY_30_ldr1
LsgY_30_ck1:
    v_max3_u32 v80, v108, v109, v110
    v_max_u32 v80, v80, v111
    v_cmp_eq_u32 vcc, -1, v80
    s_nop 4
    s_cbranch_vccnz LsgY_30_ckr1
    s_bitset0_b32 s58, 1
    s_branch LsgY_30_ckr1
LsgY_30_ld2:
    s_add_u32 s12, s56, 8192
    buffer_load_dwordx4 v[112:115], v7, s[60:63], s12 offen sc1
    s_branch LsgY_30_ldr2
LsgY_30_ck2:
    v_max3_u32 v80, v112, v113, v114
    v_max_u32 v80, v80, v115
    v_cmp_eq_u32 vcc, -1, v80
    s_nop 4
    s_cbranch_vccnz LsgY_30_ckr2
    s_bitset0_b32 s58, 2
    s_branch LsgY_30_ckr2
LsgY_30_ld3:
    s_add_u32 s12, s56, 12288
    buffer_load_dwordx4 v[116:119], v7, s[60:63], s12 offen sc1
    s_branch LsgY_30_ldr3
LsgY_30_ck3:
    v_max3_u32 v80, v116, v117, v118
    v_max_u32 v80, v80, v119
    v_cmp_eq_u32 vcc, -1, v80
    s_nop 4
    s_cbranch_vccnz LsgY_30_ckr3
    s_bitset0_b32 s58, 3
    s_branch LsgY_30_ckr3
LsgY_30_ld4:
    s_add_u32 s12, s56, 16384
    buffer_load_dwordx4 v[120:123], v7, s[60:63], s12 offen sc1
    s_branch LsgY_30_ldr4
LsgY_30_ck4:
    v_max3_u32 v80, v120, v121, v122
    v_max_u32 v80, v80, v123
    v_cmp_eq_u32 vcc, -1, v80
    s_nop 4
    s_cbranch_vccnz LsgY_30_ckr4
    s_bitset0_b32 s58, 4
    s_branch LsgY_30_ckr4
LsgY_30_ld5:
    s_add_u32 s12, s56, 20480
    buffer_load_dwordx4 v[124:127], v7, s[60:63], s12 offen sc1
    s_branch LsgY_30_ldr5
LsgY_30_ck5:
    v_max3_u32 v80, v124, v125, v126
    v_max_u32 v80, v80, v127
    v_cmp_eq_u32 vcc, -1, v80
    s_nop 4
    s_cbranch_vccnz LsgY_30_ckr5
    s_bitset0_b32 s58, 5
    s_branch LsgY_30_ckr5
LsgY_30_ld6:
    s_add_u32 s12, s56, 24576
    buffer_load_dwordx4 v[128:131], v7, s[60:63], s12 offen sc1
    s_branch LsgY_30_ldr6
LsgY_30_ck6:
    v_max3_u32 v80, v128, v129, v130
    v_max_u32 v80, v80, v131
    v_cmp_eq_u32 vcc, -1, v80
    s_nop 4
    s_cbranch_vccnz LsgY_30_ckr6
    s_bitset0_b32 s58, 6
    s_branch LsgY_30_ckr6
LsgY_30_ld7:
    s_add_u32 s12, s56, 28672
    buffer_load_dwordx4 v[132:135], v7, s[60:63], s12 offen sc1
    s_branch LsgY_30_ldr7
LsgY_30_ck7:
    v_max3_u32 v80, v132, v133, v134
    v_max_u32 v80, v80, v135
    v_cmp_eq_u32 vcc, -1, v80
    s_nop 4
    s_cbranch_vccnz LsgY_30_ckr7
    s_bitset0_b32 s58, 7
    s_branch LsgY_30_ckr7
LsgY_30_ld8:
    s_add_u32 s12, s56, 32768
    buffer_load_dwordx4 v[136:139], v7, s[60:63], s12 offen sc1
    s_branch LsgY_30_ldr8
LsgY_30_ck8:
    v_max3_u32 v80, v136, v137, v138
    v_max_u32 v80, v80, v139
    v_cmp_eq_u32 vcc, -1, v80
    s_nop 4
    s_cbranch_vccnz LsgY_30_ckr8
    s_bitset0_b32 s58, 8
    s_branch LsgY_30_ckr8
LsgY_30_ld9:
    s_add_u32 s12, s56, 36864
    buffer_load_dwordx4 v[140:143], v7, s[60:63], s12 offen sc1
    s_branch LsgY_30_ldr9
LsgY_30_ck9:
    v_max3_u32 v80, v140, v141, v142
    v_max_u32 v80, v80, v143
    v_cmp_eq_u32 vcc, -1, v80
    s_nop 4
    s_cbranch_vccnz LsgY_30_ckr9
    s_bitset0_b32 s58, 9
    s_branch LsgY_30_ckr9
LsgY_30_ld10:
    s_add_u32 s12, s56, 40960
    buffer_load_dwordx4 v[144:147], v7, s[60:63], s12 offen sc1
    s_branch LsgY_30_ldr10
LsgY_30_ck10:
    v_max3_u32 v80, v144, v145, v146
    v_max_u32 v80, v80, v147
    v_cmp_eq_u32 vcc, -1, v80
    s_nop 4
    s_cbranch_vccnz LsgY_30_ckr10
    s_bitset0_b32 s58, 10
    s_branch LsgY_30_ckr10
LsgY_30_ld11:
    s_add_u32 s12, s56, 45056
    buffer_load_dwordx4 v[148:151], v7, s[60:63], s12 offen sc1
    s_branch LsgY_30_ldr11
LsgY_30_ck11:
    v_max3_u32 v80, v148, v149, v150
    v_max_u32 v80, v80, v151
    v_cmp_eq_u32 vcc, -1, v80
    s_nop 4
    s_cbranch_vccnz LsgY_30_ckr11
    s_bitset0_b32 s58, 11
    s_branch LsgY_30_ckr11
LsgY_30_ld12:
    s_add_u32 s12, s56, 49152
    buffer_load_dwordx4 v[152:155], v7, s[60:63], s12 offen sc1
    s_branch LsgY_30_ldr12
LsgY_30_ck12:
    v_max3_u32 v80, v152, v153, v154
    v_max_u32 v80, v80, v155
    v_cmp_eq_u32 vcc, -1, v80
    s_nop 4
    s_cbranch_vccnz LsgY_30_ckr12
    s_bitset0_b32 s58, 12
    s_branch LsgY_30_ckr12
LsgY_30_ld13:
    s_add_u32 s12, s56, 53248
    buffer_load_dwordx4 v[156:159], v7, s[60:63], s12 offen sc1
    s_branch LsgY_30_ldr13
LsgY_30_ck13:
    v_max3_u32 v80, v156, v157, v158
    v_max_u32 v80, v80, v159
    v_cmp_eq_u32 vcc, -1, v80
    s_nop 4
    s_cbranch_vccnz LsgY_30_ckr13
    s_bitset0_b32 s58, 13
    s_branch LsgY_30_ckr13
LsgY_30_ld14:
    s_add_u32 s12, s56, 57344
    buffer_load_dwordx4 v[160:163], v7, s[60:63], s12 offen sc1
    s_branch LsgY_30_ldr14
LsgY_30_ck14:
    v_max3_u32 v80, v160, v161, v162
    v_max_u32 v80, v80, v163
    v_cmp_eq_u32 vcc, -1, v80
    s_nop 4
    s_cbranch_vccnz LsgY_30_ckr14
    s_bitset0_b32 s58, 14
    s_branch LsgY_30_ckr14
LsgY_30_ld15:
    s_add_u32 s12, s56, 61440
    buffer_load_dwordx4 v[164:167], v7, s[60:63], s12 offen sc1
    s_branch LsgY_30_ldr15
LsgY_30_ck15:
    v_max3_u32 v80, v164, v165, v166
    v_max_u32 v80, v80, v167
    v_cmp_eq_u32 vcc, -1, v80
    s_nop 4
    s_cbranch_vccnz LsgY_30_ckr15
    s_bitset0_b32 s58, 15
    s_branch LsgY_30_ckr15
LsgY_30_done:
    v_pk_add_f32 v[104:105], v[104:105], v[108:109]
    v_pk_add_f32 v[106:107], v[106:107], v[110:111]
    v_pk_add_f32 v[112:113], v[112:113], v[116:117]
    v_pk_add_f32 v[114:115], v[114:115], v[118:119]
    v_pk_add_f32 v[120:121], v[120:121], v[124:125]
    v_pk_add_f32 v[122:123], v[122:123], v[126:127]
    v_pk_add_f32 v[128:129], v[128:129], v[132:133]
    v_pk_add_f32 v[130:131], v[130:131], v[134:135]
    v_pk_add_f32 v[136:137], v[136:137], v[140:141]
    v_pk_add_f32 v[138:139], v[138:139], v[142:143]
    v_pk_add_f32 v[144:145], v[144:145], v[148:149]
    v_pk_add_f32 v[146:147], v[146:147], v[150:151]
    v_pk_add_f32 v[152:153], v[152:153], v[156:157]
    v_pk_add_f32 v[154:155], v[154:155], v[158:159]
    v_pk_add_f32 v[160:161], v[160:161], v[164:165]
    v_pk_add_f32 v[162:163], v[162:163], v[166:167]
    v_pk_add_f32 v[104:105], v[104:105], v[112:113]
    v_pk_add_f32 v[106:107], v[106:107], v[114:115]
    v_pk_add_f32 v[120:121], v[120:121], v[128:129]
    v_pk_add_f32 v[122:123], v[122:123], v[130:131]
    v_pk_add_f32 v[136:137], v[136:137], v[144:145]
    v_pk_add_f32 v[138:139], v[138:139], v[146:147]
    v_pk_add_f32 v[152:153], v[152:153], v[160:161]
    v_pk_add_f32 v[154:155], v[154:155], v[162:163]
    v_pk_add_f32 v[104:105], v[104:105], v[120:121]
    v_pk_add_f32 v[106:107], v[106:107], v[122:123]
    v_pk_add_f32 v[136:137], v[136:137], v[152:153]
    v_pk_add_f32 v[138:139], v[138:139], v[154:155]
    v_pk_add_f32 v[104:105], v[104:105], v[136:137]
    v_pk_add_f32 v[106:107], v[106:107], v[138:139]
    v_mov_b32 v108, v104
    v_mov_b32 v109, v105
    v_mov_b32 v110, v106
    v_mov_b32 v111, v107
    v_permlane32_swap_b32 v104, v108
    v_permlane32_swap_b32 v105, v109
    v_permlane32_swap_b32 v106, v110
    v_permlane32_swap_b32 v107, v111
    v_add_f32 v104, v104, v108
    v_add_f32 v105, v105, v109
    v_add_f32 v106, v106, v110
    v_add_f32 v107, v107, v111
    v_cvt_pk_bf16_f32 v108, v104, v105
    v_cvt_pk_bf16_f32 v109, v106, v107
    v_lshlrev_b32 v104, 16, v108
    v_and_b32 v105, s83, v108
    v_lshlrev_b32 v106, 16, v109
    v_and_b32 v107, s83, v109
    v_mul_f32 v104, v104, v52
    v_mul_f32 v105, v105, v53
    v_mul_f32 v106, v106, v54
    v_mul_f32 v107, v107, v55
    v_cvt_pk_bf16_f32 v108, v104, v105
    v_cvt_pk_bf16_f32 v109, v106, v107
    v_lshlrev_b32 v104, 16, v108
    v_and_b32 v105, s83, v108
    v_lshlrev_b32 v106, 16, v109
    v_and_b32 v107, s83, v109
    v_add_f32 v104, v104, v56
    v_add_f32 v105, v105, v57
    v_add_f32 v106, v106, v58
    v_add_f32 v107, v107, v59
    v_cvt_pk_bf16_f32 v108, v104, v105
    v_cvt_pk_bf16_f32 v109, v106, v107
    v_lshlrev_b32 v70, 16, v108
    v_and_b32 v71, s83, v108
    v_lshlrev_b32 v72, 16, v109
    v_and_b32 v73, s83, v109
    s_mov_b32 exec_lo, -1
    s_mov_b32 exec_hi, 0
    ds_write_b64 v14, v[108:109] offset:2944
    s_mov_b64 exec, -1
    v_readfirstlane_b32 s14, v70
    s_nop 1
    v_subrev_f32 v104, s14, v70
    v_subrev_f32 v105, s14, v71
    v_subrev_f32 v106, s14, v72
    v_subrev_f32 v107, s14, v73
    v_add_f32 v110, v104, v105
    v_mul_f32 v111, v104, v104
    v_fmac_f32 v111, v105, v105
    v_add_f32 v110, v110, v106
    v_fmac_f32 v111, v106, v106
    v_add_f32 v110, v110, v107
    v_fmac_f32 v111, v107, v107
    s_nop 0
    v_add_f32 v110, v110, v110 row_ror:1
    v_add_f32 v111, v111, v111 row_ror:1
    s_nop 0
    v_add_f32 v110, v110, v110 row_ror:2
    v_add_f32 v111, v111, v111 row_ror:2
    s_nop 0
    v_add_f32 v110, v110, v110 row_ror:4
    v_add_f32 v111, v111, v111 row_ror:4
    s_nop 0
    v_add_f32 v110, v110, v110 row_ror:8
    v_add_f32 v111, v111, v111 row_ror:8
    v_mov_b32 v112, v110
    v_mov_b32 v113, v111
    s_nop 0
    v_permlane16_swap_b32 v110, v112
    v_permlane16_swap_b32 v111, v113
    v_add_f32 v110, v110, v112
    v_add_f32 v111, v111, v113
    v_mul_f32 v112, 0x3c000000, v110
    v_fma_f32 v111, -v112, v110, v111
    v_add_f32 v110, s14, v112
    s_mov_b32 exec_lo, 1
    s_mov_b32 exec_hi, 0
    ds_write_b64 v15, v[110:111] offset:3968
    s_waitcnt lgkmcnt(0)
    ds_add_u32 v2, v3 offset:16
    s_mov_b64 exec, -1
    s_mov_b32 s15, 4194304
Lw_31:
    ds_read_b32 v80, v2 offset:16
    s_sub_u32 s15, s15, 1
    s_cbranch_scc1 L_end
    s_waitcnt lgkmcnt(0)
    v_readfirstlane_b32 s14, v80
    s_cmp_ge_u32 s14, 4
    s_nop 3
    s_cbranch_scc0 Lw_31
    ds_read_b128 v[104:107], v2 offset:3968
    ds_read_b128 v[108:111], v2 offset:3984
    s_waitcnt lgkmcnt(0)
    v_add_f32 v78, v104, v106
    v_add_f32 v80, v108, v110
    v_add_f32 v79, v105, v107
    v_add_f32 v81, v109, v111
    v_add_f32 v78, v78, v80
    v_add_f32 v79, v79, v81
    v_mul_f32 v78, 0x3e800000, v78
    v_sub_f32 v104, v104, v78
    v_sub_f32 v106, v106, v78
    v_sub_f32 v108, v108, v78
    v_sub_f32 v110, v110, v78
    v_mul_f32 v80, v104, v104
    v_mul_f32 v81, v106, v106
    v_fmac_f32 v80, v108, v108
    v_fmac_f32 v81, v110, v110
    v_add_f32 v80, v80, v81
    v_mul_f32 v79, 0x3b000000, v79
    v_fmac_f32 v79, 0x3e800000, v80
    v_max_f32 v79, 0, v79
    v_cvt_pk_bf16_f32 v80, v78, v79
    v_lshlrev_b32 v78, 16, v80
    v_and_b32 v79, s83, v80
    v_add_f32 v79, 0x3727c5ac, v79
    v_cvt_pk_bf16_f32 v79, v79, v79
    v_lshlrev_b32 v79, 16, v79
    v_sqrt_f32 v79, v79
    s_nop 0
    v_cvt_pk_bf16_f32 v79, v79, v79
    v_lshlrev_b32 v79, 16, v79
    v_rcp_f32 v79, v79
    v_sub_f32 v70, v70, v78
    v_sub_f32 v71, v71, v78
    v_sub_f32 v72, v72, v78
    v_sub_f32 v73, v73, v78
    v_cvt_pk_bf16_f32 v104, v70, v71
    v_cvt_pk_bf16_f32 v105, v72, v73
    v_lshlrev_b32 v70, 16, v104
    v_and_b32 v71, s83, v104
    v_lshlrev_b32 v72, 16, v105
    v_and_b32 v73, s83, v105
    v_mul_f32 v70, v70, v79
    v_mul_f32 v71, v71, v79
    v_mul_f32 v72, v72, v79
    v_mul_f32 v73, v73, v79
    v_cvt_pk_bf16_f32 v104, v70, v71
    v_cvt_pk_bf16_f32 v105, v72, v73
    v_lshlrev_b32 v70, 16, v104
    v_and_b32 v71, s83, v104
    v_lshlrev_b32 v72, 16, v105
    v_and_b32 v73, s83, v105
    v_mul_f32 v70, v70, v60
    v_mul_f32 v71, v71, v61
    v_mul_f32 v72, v72, v62
    v_mul_f32 v73, v73, v63
    v_cvt_pk_bf16_f32 v104, v70, v71
    v_cvt_pk_bf16_f32 v105, v72, v73
    v_lshlrev_b32 v70, 16, v104
    v_and_b32 v71, s83, v104
    v_lshlrev_b32 v72, 16, v105
    v_and_b32 v73, s83, v105
    v_add_f32 v70, v70, v64
    v_add_f32 v71, v71, v65
    v_add_f32 v72, v72, v66
    v_add_f32 v73, v73, v67
    v_cvt_pk_bf16_f32 v104, v70, v71
    v_cvt_pk_bf16_f32 v105, v72, v73
    s_mov_b32 exec_lo, -1
    s_mov_b32 exec_hi, 0
    ds_write_b64 v14, v[104:105] offset:5632
    s_mov_b64 exec, -1
    ds_read_b128 v[120:123], v6 offset:5632
    ds_read_b128 v[124:127], v6 offset:5696
    ds_read_b128 v[128:131], v6 offset:5760
    ds_read_b128 v[132:135], v6 offset:5824
    s_waitcnt lgkmcnt(3)
    v_mfma_f32_16x16x32_bf16 v[108:111], v[168:171], v[120:123], 0
    v_mfma_f32_16x16x32_bf16 v[112:115], v[172:175], v[120:123], 0
    s_waitcnt lgkmcnt(2)
    v_mfma_f32_16x16x32_bf16 v[108:111], v[176:179], v[124:127], v[108:111]
    v_mfma_f32_16x16x32_bf16 v[112:115], v[180:183], v[124:127], v[112:115]
    s_waitcnt lgkmcnt(1)
    v_mfma_f32_16x16x32_bf16 v[108:111], v[184:187], v[128:131], v[108:111]
    v_mfma_f32_16x16x32_bf16 v[112:115], v[188:191], v[128:131], v[112:115]
    s_waitcnt lgkmcnt(0)
    v_mfma_f32_16x16x32_bf16 v[108:111], v[192:195], v[132:135], v[108:111]
    v_mfma_f32_16x16x32_bf16 v[112:115], v[196:199], v[132:135], v[112:115]
    s_mov_b32 exec_lo, 0x00010001
    s_mov_b32 exec_hi, 0x00010001
    s_nop 4
    ds_write_b128 v16, v[108:111] offset:5120
    ds_write_b128 v16, v[112:115] offset:5184
    s_waitcnt lgkmcnt(0)
    s_mov_b32 exec_lo, 1
    s_mov_b32 exec_hi, 0
    ds_add_u32 v2, v3 offset:20
    s_mov_b64 exec, -1
    s_mov_b32 s15, 4194304
Lw_33:
    ds_read_b32 v80, v2 offset:20
    s_sub_u32 s15, s15, 1
    s_cbranch_scc1 L_end
    s_waitcnt lgkmcnt(0)
    v_readfirstlane_b32 s14, v80
    s_cmp_ge_u32 s14, 4
    s_nop 3
    s_cbranch_scc0 Lw_33
    ds_read_b128 v[104:107], v4 offset:5120
    ds_read_b128 v[108:111], v4 offset:5136
    ds_read_b128 v[112:115], v4 offset:5248
    ds_read_b128 v[116:119], v4 offset:5264
    ds_read_b128 v[120:123], v4 offset:5376
    ds_read_b128 v[124:127], v4 offset:5392
    ds_read_b128 v[128:131], v4 offset:5504
    ds_read_b128 v[132:135], v4 offset:5520
    s_waitcnt lgkmcnt(4)
    v_pk_add_f32 v[104:105], v[104:105], v[112:113]
    v_pk_add_f32 v[106:107], v[106:107], v[114:115]
    v_pk_add_f32 v[108:109], v[108:109], v[116:117]
    v_pk_add_f32 v[110:111], v[110:111], v[118:119]
    s_waitcnt lgkmcnt(0)
    v_pk_add_f32 v[120:121], v[120:121], v[128:129]
    v_pk_add_f32 v[122:123], v[122:123], v[130:131]
    v_pk_add_f32 v[124:125], v[124:125], v[132:133]
    v_pk_add_f32 v[126:127], v[126:127], v[134:135]
    v_pk_add_f32 v[104:105], v[104:105], v[120:121]
    v_pk_add_f32 v[106:107], v[106:107], v[122:123]
    v_pk_add_f32 v[108:109], v[108:109], v[124:125]
    v_pk_add_f32 v[110:111], v[110:111], v[126:127]
    v_cvt_pk_bf16_f32 v112, v104, v105
    v_cvt_pk_bf16_f32 v113, v106, v107
    v_cvt_pk_bf16_f32 v114, v108, v109
    v_cvt_pk_bf16_f32 v115, v110, v111
    v_lshlrev_b32 v104, 16, v112
    v_and_b32 v105, s83, v112
    v_lshlrev_b32 v106, 16, v113
    v_and_b32 v107, s83, v113
    v_lshlrev_b32 v108, 16, v114
    v_and_b32 v109, s83, v114
    v_lshlrev_b32 v110, 16, v115
    v_and_b32 v111, s83, v115
    v_mul_f32 v112, 0xbfb8aa3b, v104
    v_mul_f32 v113, 0xbfb8aa3b, v105
    v_mul_f32 v114, 0xbfb8aa3b, v106
    v_mul_f32 v115, 0xbfb8aa3b, v107
    v_mul_f32 v116, 0xbfb8aa3b, v108
    v_mul_f32 v117, 0xbfb8aa3b, v109
    v_mul_f32 v118, 0xbfb8aa3b, v110
    v_mul_f32 v119, 0xbfb8aa3b, v111
    v_exp_f32 v112, v112
    v_exp_f32 v113, v113
    v_exp_f32 v114, v114
    v_exp_f32 v115, v115
    v_exp_f32 v116, v116
    v_exp_f32 v117, v117
    v_exp_f32 v118, v118
    v_exp_f32 v119, v119
    v_add_f32 v112, 1.0, v112
    v_add_f32 v113, 1.0, v113
    v_add_f32 v114, 1.0, v114
    v_add_f32 v115, 1.0, v115
    v_add_f32 v116, 1.0, v116
    v_add_f32 v117, 1.0, v117
    v_add_f32 v118, 1.0, v118
    v_add_f32 v119, 1.0, v119
    v_rcp_f32 v112, v112
    v_rcp_f32 v113, v113
    v_rcp_f32 v114, v114
    v_rcp_f32 v115, v115
    v_rcp_f32 v116, v116
    v_rcp_f32 v117, v117
    v_rcp_f32 v118, v118
    v_rcp_f32 v119, v119
    v_mul_f32 v104, v104, v112
    v_mul_f32 v105, v105, v113
    v_mul_f32 v106, v106, v114
    v_mul_f32 v107, v107, v115
    v_mul_f32 v108, v108, v116
    v_mul_f32 v109, v109, v117
    v_mul_f32 v110, v110, v118
    v_mul_f32 v111, v111, v119
    v_cvt_pk_bf16_f32 v120, v104, v105
    v_cvt_pk_bf16_f32 v121, v106, v107
    v_cvt_pk_bf16_f32 v122, v108, v109
    v_cvt_pk_bf16_f32 v123, v110, v111
    s_nop 1
    v_mfma_f32_16x16x32_bf16 v[124:127], v[200:203], v[120:123], 0
    v_mfma_f32_16x16x32_bf16 v[128:131], v[204:207], v[120:123], 0
    v_mfma_f32_16x16x32_bf16 v[132:135], v[208:211], v[120:123], 0
    v_mfma_f32_16x16x32_bf16 v[136:139], v[212:215], v[120:123], 0
    v_mfma_f32_16x16x32_bf16 v[140:143], v[216:219], v[120:123], 0
    v_mfma_f32_16x16x32_bf16 v[144:147], v[220:223], v[120:123], 0
    v_mfma_f32_16x16x32_bf16 v[148:151], v[224:227], v[120:123], 0
    v_mfma_f32_16x16x32_bf16 v[152:155], v[228:231], v[120:123], 0
    s_mov_b32 exec_lo, 0x00010001
    s_mov_b32 exec_hi, 0x00010001
    buffer_store_dwordx4 v[124:127], v17, s[60:63], s88 offen offset:0 sc1
    buffer_store_dwordx4 v[128:131], v17, s[60:63], s88 offen offset:64 sc1
    buffer_store_dwordx4 v[132:135], v17, s[60:63], s88 offen offset:128 sc1
    buffer_store_dwordx4 v[136:139], v17, s[60:63], s88 offen offset:192 sc1
    buffer_store_dwordx4 v[140:143], v17, s[60:63], s88 offen offset:256 sc1
    buffer_store_dwordx4 v[144:147], v17, s[60:63], s88 offen offset:320 sc1
    buffer_store_dwordx4 v[148:151], v17, s[60:63], s88 offen offset:384 sc1
    buffer_store_dwordx4 v[152:155], v17, s[60:63], s88 offen offset:448 sc1
    s_mov_b64 exec, -1
    s_cmp_ge_u32 s5, 8
    s_cbranch_scc1 L_end
    v_lshrrev_b32 v8, 2, v0
    v_lshlrev_b32 v18, 11, v8
    v_and_b32 v9, 3, v0
    v_lshl_add_u32 v18, v9, 4, v18
    v_and_b32 v8, 7, v8
    v_lshlrev_b32 v10, 11, v8
    v_lshl_add_u32 v10, v9, 4, v10
    s_lshl_b32 s12, s4, 7
    s_lshl_b32 s13, s3, 5
    s_add_u32 s14, s12, s13
    v_lshlrev_b32 v9, 3, v9
    v_add_u32 v9, s14, v9
    ds_read_b64 v[58:59], v9 offset:2944
    s_mov_b32 s44, s90
    s_mov_b32 s45, s91
    s_mov_b32 s46, 0x400
    s_mov_b32 s47, 0x20000
    s_mov_b32 s58, 0
    s_mov_b32 s15, 262144
LsgZ_35_all:
    s_add_u32 s12, s57, 0
    buffer_load_dwordx4 v[104:107], v18, s[60:63], s12 offen sc1
    s_add_u32 s12, s57, 32768
    buffer_load_dwordx4 v[108:111], v18, s[60:63], s12 offen sc1
    s_add_u32 s12, s57, 65536
    buffer_load_dwordx4 v[112:115], v18, s[60:63], s12 offen sc1
    s_add_u32 s12, s57, 98304
    buffer_load_dwordx4 v[116:119], v10, s[60:63], s12 offen sc1
    s_sub_u32 s15, s15, 1
    s_cbranch_scc1 L_end
    s_waitcnt vmcnt(0)
    s_mov_b32 s58, 0
    v_max3_u32 v80, v104, v105, v106
    v_max_u32 v80, v80, v107
    v_cmp_eq_u32 vcc, -1, v80
    s_cmp_lg_u64 vcc, 0
    s_cselect_b32 s14, 0x1, 0
    s_or_b32 s58, s58, s14
    v_max3_u32 v80, v108, v109, v110
    v_max_u32 v80, v80, v111
    v_cmp_eq_u32 vcc, -1, v80
    s_cmp_lg_u64 vcc, 0
    s_cselect_b32 s14, 0x2, 0
    s_or_b32 s58, s58, s14
    v_max3_u32 v80, v112, v113, v114
    v_max_u32 v80, v80, v115
    v_cmp_eq_u32 vcc, -1, v80
    s_cmp_lg_u64 vcc, 0
    s_cselect_b32 s14, 0x4, 0
    s_or_b32 s58, s58, s14
    v_max3_u32 v80, v116, v117, v118
    v_max_u32 v80, v80, v119
    v_cmp_eq_u32 vcc, -1, v80
    s_cmp_lg_u64 vcc, 0
    s_cselect_b32 s14, 0x8, 0
    s_or_b32 s58, s58, s14
    s_cmp_eq_u32 s58, 0
    s_cbranch_scc1 LsgZ_35_done
LsgZ_35:
    s_bitcmp1_b32 s58, 0
    s_cbranch_scc1 LsgZ_35_ld0
LsgZ_35_ldr0:
    s_bitcmp1_b32 s58, 1
    s_cbranch_scc1 LsgZ_35_ld1
LsgZ_35_ldr1:
    s_bitcmp1_b32 s58, 2
    s_cbranch_scc1 LsgZ_35_ld2
LsgZ_35_ldr2:
    s_bitcmp1_b32 s58, 3
    s_cbranch_scc1 LsgZ_35_ld3
LsgZ_35_ldr3:
    s_sub_u32 s15, s15, 1
    s_cbranch_scc1 L_end
    s_waitcnt vmcnt(0)
    s_bitcmp1_b32 s58, 0
    s_cbranch_scc1 LsgZ_35_ck0
LsgZ_35_ckr0:
    s_bitcmp1_b32 s58, 1
    s_cbranch_scc1 LsgZ_35_ck1
LsgZ_35_ckr1:
    s_bitcmp1_b32 s58, 2
    s_cbranch_scc1 LsgZ_35_ck2
LsgZ_35_ckr2:
    s_bitcmp1_b32 s58, 3
    s_cbranch_scc1 LsgZ_35_ck3
LsgZ_35_ckr3:
    s_cmp_lg_u32 s58, 0
    s_cbranch_scc1 LsgZ_35
    s_branch LsgZ_35_done
LsgZ_35_ld0:
    s_add_u32 s12, s57, 0
    buffer_load_dwordx4 v[104:107], v18, s[60:63], s12 offen sc1
    s_branch LsgZ_35_ldr0
LsgZ_35_ck0:
    v_max3_u32 v80, v104, v105, v106
    v_max_u32 v80, v80, v107
    v_cmp_eq_u32 vcc, -1, v80
    s_nop 4
    s_cbranch_vccnz LsgZ_35_ckr0
    s_bitset0_b32 s58, 0
    s_branch LsgZ_35_ckr0
LsgZ_35_ld1:
    s_add_u32 s12, s57, 32768
    buffer_load_dwordx4 v[108:111], v18, s[60:63], s12 offen sc1
    s_branch LsgZ_35_ldr1
LsgZ_35_ck1:
    v_max3_u32 v80, v108, v109, v110
    v_max_u32 v80, v80, v111
    v_cmp_eq_u32 vcc, -1, v80
    s_nop 4
    s_cbranch_vccnz LsgZ_35_ckr1
    s_bitset0_b32 s58, 1
    s_branch LsgZ_35_ckr1
LsgZ_35_ld2:
    s_add_u32 s12, s57, 65536
    buffer_load_dwordx4 v[112:115], v18, s[60:63], s12 offen sc1
    s_branch LsgZ_35_ldr2
LsgZ_35_ck2:
    v_max3_u32 v80, v112, v113, v114
    v_max_u32 v80, v80, v115
    v_cmp_eq_u32 vcc, -1, v80
    s_nop 4
    s_cbranch_vccnz LsgZ_35_ckr2
    s_bitset0_b32 s58, 2
    s_branch LsgZ_35_ckr2
LsgZ_35_ld3:
    s_add_u32 s12, s57, 98304
    buffer_load_dwordx4 v[116:119], v10, s[60:63], s12 offen sc1
    s_branch LsgZ_35_ldr3
LsgZ_35_ck3:
    v_max3_u32 v80, v116, v117, v118
    v_max_u32 v80, v80, v119
    v_cmp_eq_u32 vcc, -1, v80
    s_nop 4
    s_cbranch_vccnz LsgZ_35_ckr3
    s_bitset0_b32 s58, 3
    s_branch LsgZ_35_ckr3
LsgZ_35_done:
    s_mov_b32 exec_lo, 0
    s_mov_b32 exec_hi, -1
    v_mov_b32 v116, 0
    v_mov_b32 v117, 0
    v_mov_b32 v118, 0
    v_mov_b32 v119, 0
    s_mov_b64 exec, -1
    v_pk_add_f32 v[104:105], v[104:105], v[108:109]
    v_pk_add_f32 v[106:107], v[106:107], v[110:111]
    v_pk_add_f32 v[112:113], v[112:113], v[116:117]
    v_pk_add_f32 v[114:115], v[114:115], v[118:119]
    v_pk_add_f32 v[104:105], v[104:105], v[112:113]
    v_pk_add_f32 v[106:107], v[106:107], v[114:115]
    s_nop 0
    v_add_f32 v104, v104, v104 row_ror:4
    v_add_f32 v105, v105, v105 row_ror:4
    v_add_f32 v106, v106, v106 row_ror:4
    v_add_f32 v107, v107, v107 row_ror:4
    v_add_f32 v104, v104, v104 row_ror:8
    v_add_f32 v105, v105, v105 row_ror:8
    v_add_f32 v106, v106, v106 row_ror:8
    v_add_f32 v107, v107, v107 row_ror:8
    v_mov_b32 v108, v104
    v_mov_b32 v109, v105
    v_mov_b32 v110, v106
    v_mov_b32 v111, v107
    v_permlane16_swap_b32 v104, v108
    v_permlane16_swap_b32 v105, v109
    v_permlane16_swap_b32 v106, v110
    v_permlane16_swap_b32 v107, v111
    v_add_f32 v104, v104, v108
    v_add_f32 v105, v105, v109
    v_add_f32 v106, v106, v110
    v_add_f32 v107, v107, v111
    v_mov_b32 v108, v104
    v_mov_b32 v109, v105
    v_mov_b32 v110, v106
    v_mov_b32 v111, v107
    v_permlane32_swap_b32 v104, v108
    v_permlane32_swap_b32 v105, v109
    v_permlane32_swap_b32 v106, v110
    v_permlane32_swap_b32 v107, v111
    v_add_f32 v104, v104, v108
    v_add_f32 v105, v105, v109
    v_add_f32 v106, v106, v110
    v_add_f32 v107, v107, v111
    s_waitcnt lgkmcnt(0)
    v_lshlrev_b32 v56, 16, v58
    v_and_b32 v57, s83, v58
    v_lshlrev_b32 v58, 16, v59
    v_and_b32 v59, s83, v59
    v_cvt_pk_bf16_f32 v108, v104, v105
    v_cvt_pk_bf16_f32 v109, v106, v107
    v_lshlrev_b32 v104, 16, v108
    v_and_b32 v105, s83, v108
    v_lshlrev_b32 v106, 16, v109
    v_and_b32 v107, s83, v109
    v_mul_f32 v104, v104, v240
    v_mul_f32 v105, v105, v241
    v_mul_f32 v106, v106, v242
    v_mul_f32 v107, v107, v243
    v_cvt_pk_bf16_f32 v108, v104, v105
    v_cvt_pk_bf16_f32 v109, v106, v107
    v_lshlrev_b32 v104, 16, v108
    v_and_b32 v105, s83, v108
    v_lshlrev_b32 v106, 16, v109
    v_and_b32 v107, s83, v109
    v_add_f32 v104, v104, v56
    v_add_f32 v105, v105, v57
    v_add_f32 v106, v106, v58
    v_add_f32 v107, v107, v59
    v_cvt_pk_bf16_f32 v108, v104, v105
    v_cvt_pk_bf16_f32 v109, v106, v107
    s_mov_b32 exec_lo, 0xf
    s_mov_b32 exec_hi, 0
    buffer_store_dwordx2 v[108:109], v9, s[44:47], 0 offen sc1
    s_or_b32 s12, s5, s3
    s_cmp_lg_u32 s12, 0
    s_cbranch_scc1 L_noep
    s_mov_b32 exec_lo, 1
    s_mov_b32 exec_hi, 0
    buffer_store_dword v102, v2, s[60:63], 0 offen offset:0 sc1
L_noep:
    s_mov_b64 exec, -1
L_end:
L_exit:
    s_endpgm
.section .rodata,"a"
.p2align 6
.amdhsa_kernel adaLN_cond__gqa_block_cached__dense_activation_silu__decode_kernel
  .amdhsa_next_free_vgpr 256
  .amdhsa_next_free_sgpr 100
  .amdhsa_accum_offset 256
  .amdhsa_group_segment_fixed_size 0
  .amdhsa_kernarg_size 104
  .amdhsa_user_sgpr_count 2
  .amdhsa_user_sgpr_kernarg_segment_ptr 1
  .amdhsa_system_sgpr_workgroup_id_x 1
.end_amdhsa_kernel
```
